```python
import torch

def _softmax(x, axis=-1):
    return torch.softmax(x, dim=axis)
def _gelu(x):
    return torch.nn.functional.gelu(x, approximate="tanh")
def _silu(x):
    return torch.nn.functional.silu(x)
def _sigmoid(x):
    return torch.sigmoid(x)
def _layernorm(x, axis=-1, eps=1e-5):
    m = x.mean(dim=axis, keepdim=True)
    v = x.var(dim=axis, keepdim=True, unbiased=False)
    return (x - m) / torch.sqrt(v + eps)
def _scatter_add(tgt, idx, src, axis=0):
    return tgt.clone().index_add_(axis, idx, src)
def _segment_sum(src, seg, n):
    out = torch.zeros((n,) + src.shape[1:], dtype=src.dtype)
    return out.index_add_(0, seg, src)
def _pad(x, pw):
    flat = tuple(v for pair in reversed(pw) for v in pair)
    return torch.nn.functional.pad(x, flat)

kernel_name = 'sequential_preLN__sliding_block_cached__dense_activation_gelu__decode'

def setup_inputs():

    _w = (lambda a: (lambda t: t.to(torch.bfloat16) if t.is_floating_point() else t)(torch.as_tensor(a)))
    def _A_setup():
        B, Sq, D = 8, 1, 512
        Hq, Hkv, Sk, Dh = 32, 32, 4096, 128
        assert Hq % Hkv == 0, (Hq, Hkv)
        return {
            "x": _w((lambda *s: torch.randn(*s, dtype=torch.bfloat16) * 0.05)(B, Sq, D)),
            "k_cache": _w((lambda *s: torch.randn(*s, dtype=torch.bfloat16) * 1.6)(B, Hkv, Sk, Dh)),
            "v_cache": _w((lambda *s: torch.randn(*s, dtype=torch.bfloat16) * 0.4)(B, Hkv, Sk, Dh)),
            "wq": _w((lambda *s: torch.randn(*s, dtype=torch.bfloat16) * 1.6)(D, Hq * Dh) * (D ** -0.5)),
            "wo": _w((lambda *s: torch.randn(*s, dtype=torch.bfloat16) * 0.4)(Hq * Dh, D) * ((Hq * Dh) ** -0.5)),
        }
    _A_in = _A_setup()

    def _B_setup():
        B, S, D, F = 8, 1, 512, 1376
        return {
            "x": _w((lambda *s: torch.randn(*s, dtype=torch.bfloat16) * 0.05)(B, S, D)),
            "w1": _w((lambda *s: torch.randn(*s, dtype=torch.bfloat16) * 0.8)(D, F) * (D ** -0.5)),
            "b1": _w((lambda *s: torch.randn(*s, dtype=torch.bfloat16) * 0.8)(F) * 0.01),
            "w2": _w((lambda *s: torch.randn(*s, dtype=torch.bfloat16) * 0.1)(F, D) * (F ** -0.5)),
            "b2": _w((lambda *s: torch.randn(*s, dtype=torch.bfloat16) * 0.1)(D) * 0.01),
        }
    _B_in = _B_setup()

    return {
        "A_x": _A_in["x"],
        "A_k_cache": _A_in["k_cache"],
        "A_v_cache": _A_in["v_cache"],
        "A_wq": _A_in["wq"],
        "A_wo": _A_in["wo"],
        "B_x": _B_in["x"],
        "B_w1": _B_in["w1"],
        "B_b1": _B_in["b1"],
        "B_w2": _B_in["w2"],
        "B_b2": _B_in["b2"],
    }

def reference(A_x, A_k_cache, A_v_cache, A_wq, A_wo, B_x, B_w1, B_b1, B_w2, B_b2):
    def _A_ref(x, k_cache, v_cache, wq, wo):
        B, Sq, D = x.shape
        Hq, Dh = 32, 128
        Hkv, Sk = k_cache.shape[1], k_cache.shape[2]
        W = min(4096, max(256, Sk // 4))
        rep = Hq // Hkv
        q = (lambda x, *d: x.permute(*d))((x @ wq).reshape(B, Sq, Hq, Dh), 0, 2, 1, 3)
        k = (lambda x, n, axis: torch.repeat_interleave(x, n, dim=axis))(k_cache[:, :, Sk - W:, :], rep, axis=1)
        v = (lambda x, n, axis: torch.repeat_interleave(x, n, dim=axis))(v_cache[:, :, Sk - W:, :], rep, axis=1)
        scores = torch.einsum("bhqd,bhkd->bhqk", q, k) * (Dh ** -0.5)
        p = _softmax(scores, axis=-1)
        o = torch.einsum("bhqk,bhkd->bhqd", p, v)
        return (lambda x, *d: x.permute(*d))(o, 0, 2, 1, 3).reshape(B, Sq, Hq * Dh) @ wo

    def _B_ref(x, w1, b1, w2, b2):
        h = torch.einsum("bsd,df->bsf", x, w1) + b1
        h = _gelu(h)
        return torch.einsum("bsf,fd->bsd", h, w2) + b2

    x = A_x
    h = x + _A_ref(_layernorm(x, axis=-1), A_k_cache, A_v_cache, A_wq, A_wo)
    h2 = h + _B_ref(_layernorm(h, axis=-1), B_w1, B_b1, B_w2, B_b2)
    return h2
```

```asm
; @launch grid=(256,1,1) block=(512,1,1) lds=68096
.amdgcn_target "amdgcn-amd-amdhsa--gfx950"
.text
.globl sequential_preLN__sliding_block_cached__dense_activation_gelu__decode_kernel
.p2align 8
.type sequential_preLN__sliding_block_cached__dense_activation_gelu__decode_kernel,@function
sequential_preLN__sliding_block_cached__dense_activation_gelu__decode_kernel:
    s_load_dwordx2 s[36:37], s[0:1], 8
    s_load_dwordx2 s[44:45], s[0:1], 24
    s_load_dwordx2 s[68:69], s[0:1], 96
    s_load_dwordx2 s[48:49], s[0:1], 32
    s_cmp_ge_u32 s2, 256
    s_cbranch_scc1 L_end
    s_bfe_u32 s6, s2, 0x20003
    v_and_b32 v58, 0x7f, v0
    v_lshlrev_b32 v58, 4, v58
    v_bfe_u32 v24, v0, 7, 2
    v_lshl_add_u32 v58, v24, 13, v58
    s_add_u32 s5, s2, s6
    s_and_b32 s5, s5, 3
    s_and_b32 s52, s2, 0xfc
    s_or_b32 s5, s52, s5
    s_lshl_b32 s52, s5, 20
    s_or_b32 s52, s52, 0xc0000
    s_mov_b32 s38, 0x10000000
    s_mov_b32 s39, 0x20000
    s_mov_b32 s53, s52
    v_lshrrev_b32 v1, 6, v0
    v_and_b32 v0, 63, v0
    v_readfirstlane_b32 s3, v1
    s_and_b32 s5, s5, 31
    s_waitcnt lgkmcnt(0)
    buffer_load_dwordx4 v[128:131], v58, s[36:39], s52 offen offset:0 nt
    v_lshlrev_b32 v1, 4, v0
    v_lshrrev_b32 v44, 4, v0
    v_and_b32 v45, 15, v0
    s_mov_b32 s46, 0x400000
    s_mov_b32 s47, 0x20000
    v_lshlrev_b32 v54, 17, v44
    v_lshl_add_u32 v54, v45, 4, v54
    s_lshl_b32 s54, s3, 19
    s_lshl_b32 s6, s5, 8
    s_add_u32 s54, s54, s6
    s_lshr_b32 s4, s2, 5
    s_lshl_b32 s6, s4, 14
    s_add_u32 s54, s54, s6
    s_xor_b32 s66, s54, 0x0
    buffer_load_dwordx4 v[64:67], v54, s[44:47], s66 offen
    s_xor_b32 s66, s54, 0x2000
    buffer_load_dwordx4 v[68:71], v54, s[44:47], s66 offen
    s_mov_b32 s50, 0x400000
    s_mov_b32 s51, 0x20000
    v_and_b32 v32, 7, v0
    v_lshrrev_b32 v55, 3, v0
    v_lshlrev_b32 v55, 13, v55
    v_lshl_add_u32 v55, v32, 4, v55
    s_lshl_b32 s55, s5, 17
    s_lshl_b32 s6, s3, 7
    s_add_u32 s55, s55, s6
    s_and_b32 s6, s4, 3
    s_lshl_b32 s6, s6, 11
    s_add_u32 s55, s55, s6
    s_lshr_b32 s6, s4, 2
    s_lshl_b32 s6, s6, 16
    s_add_u32 s55, s55, s6
    s_xor_b32 s67, s55, 0x0
    buffer_load_dwordx4 v[240:243], v55, s[48:51], s67 offen
    s_xor_b32 s67, s55, 0x400
    buffer_load_dwordx4 v[244:247], v55, s[48:51], s67 offen
    s_lshl3_add_u32 s7, s4, s3
    s_lshr_b32 s6, s2, 5
    s_lshl3_add_u32 s6, s6, s3
    s_lshl_b32 s6, s6, 5
    s_and_b32 s7, s2, 7
    s_lshl2_add_u32 s6, s7, s6
    s_lshr_b32 s7, s5, 3
    s_add_u32 s6, s6, s7
    s_lshl_b32 s6, s6, 7
    v_bfe_u32 v29, v0, 3, 3
    v_and_b32 v28, 0x70, v1
    v_lshl_add_u32 v28, v29, 18, v28
    v_add_u32 v28, s6, v28
    s_lshr_b32 s7, 0xe2222222, s5
    s_and_b32 s7, s7, 1
    v_and_b32 v29, s7, v29
    v_add_u32 v40, -1, v29
    v_mov_b32 v41, v40
    v_mov_b32 v42, v40
    v_mov_b32 v43, v40
    s_mov_b64 exec, 0xffff
    global_store_dwordx4 v28, v[40:43], s[68:69] sc1
    s_mov_b64 exec, -1
    s_load_dwordx16 s[8:23], s[0:1], 0
    s_load_dwordx8 s[24:31], s[0:1], 64
    s_load_dwordx2 s[32:33], s[0:1], 96
    s_getpc_b64 s[34:35]
L_pc:
    s_waitcnt vmcnt(5)
    buffer_load_dwordx4 v[132:135], v58, s[36:39], s52 offen offset:2048 nt
    s_add_u32 s52, s52, 0x1000
    s_lshr_b32 s4, s2, 5
    v_and_b32 v24, 1, v0
    v_lshlrev_b32 v24, 4, v24
    v_mov_b32 v25, 0xffff
    v_lshlrev_b32 v24, v24, v25
    s_mov_b32 s56, 0x330033
    s_mov_b32 s57, 0x330033
    v_cndmask_b32_e64 v2, 0, v24, s[56:57]
    s_mov_b32 s56, 0xcc00cc
    s_mov_b32 s57, 0xcc00cc
    v_cndmask_b32_e64 v3, 0, v24, s[56:57]
    s_mov_b32 s56, 0x33003300
    s_mov_b32 s57, 0x33003300
    v_cndmask_b32_e64 v4, 0, v24, s[56:57]
    s_mov_b32 s56, 0xcc00cc00
    s_mov_b32 s57, 0xcc00cc00
    v_cndmask_b32_e64 v5, 0, v24, s[56:57]
    s_mov_b32 s56, 0xcccccccc
    s_mov_b32 s57, 0xcccccccc
    s_mov_b32 s58, 0xaaaaaaaa
    s_waitcnt vmcnt(5)
    buffer_load_dwordx4 v[136:139], v58, s[36:39], s52 offen offset:0 nt
    s_mov_b32 s59, 0xaaaaaaaa
    v_and_b32 v24, 7, v0
    v_bfe_u32 v25, v0, 3, 1
    s_lshl_b32 s6, s3, 7
    s_add_u32 s64, s5, 2
    s_lshr_b32 s64, s64, 2
    s_sub_u32 s64, s5, s64
    s_and_b32 s7, s5, 3
    s_cmp_eq_u32 s7, 1
    s_cselect_b32 s64, 31, s64
    s_lshl_b32 s7, s64, 6
    v_lshl_add_u32 v26, v24, 3, s7
    v_min_u32 v26, 0x558, v26
    v_lshl_add_u32 v27, v25, 4, v44
    v_mul_u32_u24 v27, 0x1580, v27
    v_lshl_add_u32 v56, v26, 1, v27
    v_lshl_add_u32 v26, v45, 2, s7
    v_min_u32 v26, 0x55c, v26
    s_waitcnt vmcnt(5)
    s_xor_b32 s67, s55, 0x800
    buffer_load_dwordx4 v[248:251], v55, s[48:51], s67 offen
    v_and_b32 v27, 16, v0
    v_and_b32 v56, 2, v44
    v_add_u32 v27, v27, v56
    v_mul_u32_u24 v27, 0xac0, v27
    v_lshl_add_u32 v56, v26, 1, v27
    v_and_b32 v26, 1, v44
    v_lshl_add_u32 v26, v25, 3, v26
    v_lshrrev_b32 v27, 1, v44
    v_lshl_add_u32 v26, v27, 4, v26
    v_lshlrev_b32 v26, 10, v26
    v_lshl_add_u32 v57, v24, 4, v26
    v_lshlrev_b32 v47, 3, v25
    v_lshl_add_u32 v47, v44, 7, v47
    v_bfe_u32 v26, v0, 1, 1
    v_lshl_add_u32 v47, v26, 6, v47
    v_and_b32 v26, 1, v0
    v_lshl_add_u32 v47, v26, 4, v47
    v_bfe_u32 v26, v0, 2, 1
    v_lshl_add_u32 v47, v26, 5, v47
    s_and_b32 s62, s4, 3
    s_waitcnt vmcnt(5)
    buffer_load_dwordx4 v[140:143], v58, s[36:39], s52 offen offset:2048 nt
    s_add_u32 s52, s52, 0x7000
    s_lshl_b32 s62, s62, 3
    s_lshr_b32 s63, s4, 2
    s_lshl_b32 s63, s63, 8
    s_or_b32 s62, s62, s63
    v_xor_b32 v47, s62, v47
    v_add_u32 v47, 6272, v47
    v_and_b32 v27, 3, v0
    v_lshl_add_u32 v27, v25, 2, v27
    v_lshl_add_u32 v27, v26, 3, v27
    v_lshl_add_u32 v27, v44, 4, v27
    s_mov_b32 s65, 0
    s_mov_b32 s63, 0
    v_xor_b32 v27, s65, v27
    v_lshlrev_b32 v52, 2, v27
    v_add_u32 v52, 10752, v52
    v_add_u32 v27, s7, v27
    v_min_u32 v27, 0x55f, v27
    v_lshlrev_b32 v10, 1, v27
    s_waitcnt vmcnt(5)
    buffer_load_dwordx4 v[144:147], v58, s[36:39], s52 offen offset:0 nt
    s_and_b32 s62, s63, 7
    s_lshr_b32 s62, s62, 1
    v_xor_b32 v27, s62, v24
    v_lshl_add_u32 v27, v27, 3, v25
    v_lshl_add_u32 v27, v44, 1, v27
    v_lshl_add_u32 v53, v27, 1, s6
    s_lshl_b32 s62, s4, 1
    v_xor_b32 v6, s62, v0
    v_lshl_add_u32 v6, v6, 1, s6
    v_lshrrev_b32 v26, 1, v44
    v_lshlrev_b32 v51, 12, v25
    v_lshl_add_u32 v51, v26, 11, v51
    v_lshl_add_u32 v51, v24, 5, v51
    v_and_b32 v27, 16, v0
    s_lshl_b32 s7, s3, 8
    v_add3_u32 v51, v51, v27, s7
    v_lshlrev_b32 v51, 11, v26
    v_lshl_add_u32 v51, v45, 4, v51
    v_lshrrev_b32 v27, 1, v27
    v_add3_u32 v51, v51, v27, s7
    s_waitcnt vmcnt(4)
    s_xor_b32 s66, s54, 0x4000
    buffer_load_dwordx4 v[72:75], v54, s[44:47], s66 offen
    v_lshl_add_u32 v59, v0, 2, s7
    v_lshlrev_b32 v26, 4, v26
    v_lshl_add_u32 v26, v45, 5, v26
    s_lshl_b32 s7, s3, 9
    v_add_u32 v46, s7, v26
    v_lshlrev_b32 v49, 2, v0
    v_add_u32 v49, 128, v49
    s_lshl_b32 s7, s3, 4
    s_add_u32 s62, s7, 4
    v_writelane_b32 v49, s62, 0
    s_add_u32 s62, s7, 12
    v_writelane_b32 v49, s62, 20
    s_add_u32 s62, s7, 0
    v_writelane_b32 v49, s62, 32
    s_add_u32 s62, s7, 8
    v_writelane_b32 v49, s62, 36
    v_lshlrev_b32 v50, 3, v45
    s_and_b32 s7, s2, 7
    s_lshl_b32 s7, s7, 2
    s_waitcnt vmcnt(4)
    buffer_load_dwordx4 v[148:151], v58, s[36:39], s52 offen offset:2048 nt
    s_add_u32 s52, s52, 0x1000
    s_lshr_b32 s62, s5, 3
    s_add_u32 s7, s7, s62
    s_lshl_b32 s63, s7, 7
    v_lshlrev_b32 v48, 4, v24
    v_lshl_add_u32 v48, v44, 2, v48
    v_add_u32 v48, s63, v48
    s_waitcnt lgkmcnt(0)
    s_mov_b32 s1, s64
    s_lshl_b32 s11, s1, 16
    s_add_u32 s11, s11, s6
    s_lshl_b32 s65, s65, 10
    s_add_u32 s11, s11, s65
    s_mov_b32 s0, 0
    s_mul_i32 s10, s3, 176128
    s_mov_b32 s40, s12
    s_and_b32 s41, s13, 0xffff
    s_mov_b32 s42, 0x10000000
    s_mov_b32 s43, 0x20000
    s_lshl_b32 s6, s4, 3
    s_add_u32 s6, s6, s3
    s_waitcnt vmcnt(4)
    buffer_load_dwordx4 v[152:155], v58, s[36:39], s52 offen offset:0 nt
    s_lshl_b32 s6, s6, 12
    s_add_u32 s60, s32, s6
    s_addc_u32 s61, s33, 0
    s_mul_i32 s70, s6, 0
    s_add_u32 s70, s70, 0x40000
    s_lshr_b32 s6, s2, 3
    s_and_b32 s6, s6, 15
    s_lshl_b32 s6, s6, 3
    s_add_u32 s6, s6, s3
    s_lshl_b32 s6, s6, 7
    s_load_dword s65, s[34:35], s6
    s_lshl_b32 s6, s4, 10
    s_add_u32 s8, s8, s6
    s_addc_u32 s9, s9, 0
    s_add_u32 s28, s28, s6
    s_addc_u32 s29, s29, 0
    s_waitcnt vmcnt(4)
    s_xor_b32 s66, s54, 0x6000
    buffer_load_dwordx4 v[76:79], v54, s[44:47], s66 offen
    s_waitcnt vmcnt(4)
    buffer_load_dwordx4 v[156:159], v58, s[36:39], s52 offen offset:2048 nt
    s_add_u32 s52, s52, 0x7000
    s_waitcnt vmcnt(4)
    buffer_load_dwordx4 v[160:163], v58, s[36:39], s52 offen offset:0 nt
    s_barrier
    s_cmp_lg_u32 s3, 7
    s_cbranch_scc1 L_nosig
    s_lshl_b32 s6, s4, 5
    s_mov_b32 s71, 1
    s_atomic_add s71, s[30:31], s6
L_nosig:
    s_waitcnt vmcnt(4)
    s_xor_b32 s67, s55, 0xc00
    buffer_load_dwordx4 v[252:255], v55, s[48:51], s67 offen
    s_waitcnt vmcnt(4)
    buffer_load_dwordx4 v[164:167], v58, s[36:39], s52 offen offset:2048 nt
    s_add_u32 s52, s52, 0x1000
    s_waitcnt vmcnt(4)
    s_xor_b32 s66, s54, 0x8000
    buffer_load_dwordx4 v[80:83], v54, s[44:47], s66 offen
    s_waitcnt vmcnt(4)
    buffer_load_dwordx4 v[168:171], v58, s[36:39], s52 offen offset:0 nt
    s_waitcnt vmcnt(4)
    buffer_load_dwordx4 v[172:175], v58, s[36:39], s52 offen offset:2048 nt
    s_add_u32 s52, s52, 0x7000
    s_waitcnt vmcnt(4)
    s_xor_b32 s66, s54, 0xa000
    buffer_load_dwordx4 v[84:87], v54, s[44:47], s66 offen
    s_waitcnt vmcnt(4)
    buffer_load_dwordx4 v[176:179], v58, s[36:39], s52 offen offset:0 nt
    s_waitcnt vmcnt(4)
    buffer_load_dwordx4 v[180:183], v58, s[36:39], s52 offen offset:2048 nt
    s_add_u32 s52, s52, 0x1000
    s_waitcnt vmcnt(4)
    s_xor_b32 s66, s54, 0xc000
    buffer_load_dwordx4 v[88:91], v54, s[44:47], s66 offen
    s_waitcnt vmcnt(4)
    buffer_load_dwordx4 v[184:187], v58, s[36:39], s52 offen offset:0 nt
    global_load_dwordx4 v[12:15], v1, s[8:9]
    global_load_ushort v6, v6, s[8:9]
    s_waitcnt vmcnt(6)
    buffer_load_dwordx4 v[188:191], v58, s[36:39], s52 offen offset:2048 nt
    s_add_u32 s52, s52, 0x7000
    s_waitcnt vmcnt(6)
    s_xor_b32 s66, s54, 0xe000
    buffer_load_dwordx4 v[92:95], v54, s[44:47], s66 offen
    s_waitcnt vmcnt(6)
    buffer_load_dwordx4 v[192:195], v58, s[36:39], s52 offen offset:0 nt
    s_waitcnt vmcnt(6)
    s_xor_b32 s66, s54, 0x10000
    buffer_load_dwordx4 v[96:99], v54, s[44:47], s66 offen
    s_waitcnt vmcnt(6)
    buffer_load_dwordx4 v[196:199], v58, s[36:39], s52 offen offset:2048 nt
    s_add_u32 s52, s52, 0x1000
    s_waitcnt vmcnt(4)
    buffer_load_dwordx4 v[200:203], v58, s[36:39], s52 offen offset:0 nt
    v_lshlrev_b32 v32, 16, v12
    v_and_b32 v33, 0xffff0000, v12
    v_lshlrev_b32 v34, 16, v13
    v_and_b32 v35, 0xffff0000, v13
    v_lshlrev_b32 v36, 16, v14
    v_and_b32 v37, 0xffff0000, v14
    v_lshlrev_b32 v38, 16, v15
    v_and_b32 v39, 0xffff0000, v15
    v_lshlrev_b32 v6, 16, v6
    v_readfirstlane_b32 s62, v32
    s_nop 1
    v_mov_b32 v30, s62
    v_mov_b32 v31, s62
    v_pk_add_f32 v[32:33], v[32:33], v[30:31] neg_lo:[0,1] neg_hi:[0,1]
    v_pk_add_f32 v[34:35], v[34:35], v[30:31] neg_lo:[0,1] neg_hi:[0,1]
    v_pk_add_f32 v[36:37], v[36:37], v[30:31] neg_lo:[0,1] neg_hi:[0,1]
    v_pk_add_f32 v[38:39], v[38:39], v[30:31] neg_lo:[0,1] neg_hi:[0,1]
    v_pk_mul_f32 v[26:27], v[32:33], v[32:33]
    v_pk_add_f32 v[28:29], v[32:33], v[34:35]
    v_pk_fma_f32 v[26:27], v[34:35], v[34:35], v[26:27]
    v_pk_add_f32 v[32:33], v[36:37], v[38:39]
    v_pk_fma_f32 v[26:27], v[36:37], v[36:37], v[26:27]
    v_pk_add_f32 v[28:29], v[28:29], v[32:33]
    v_pk_fma_f32 v[26:27], v[38:39], v[38:39], v[26:27]
    v_add_f32 v24, v28, v29
    v_add_f32 v25, v26, v27
    v_mov_b32 v26, 0x3b000000
    v_add_f32_dpp v24, v24, v24 row_ror:8 row_mask:0xf bank_mask:0xf
    v_add_f32_dpp v25, v25, v25 row_ror:8 row_mask:0xf bank_mask:0xf
    s_nop 0
    v_add_f32_dpp v24, v24, v24 row_ror:4 row_mask:0xf bank_mask:0xf
    v_add_f32_dpp v25, v25, v25 row_ror:4 row_mask:0xf bank_mask:0xf
    s_nop 0
    v_add_f32_dpp v24, v24, v24 row_ror:2 row_mask:0xf bank_mask:0xf
    v_add_f32_dpp v25, v25, v25 row_ror:2 row_mask:0xf bank_mask:0xf
    s_nop 0
    v_add_f32_dpp v24, v24, v24 row_ror:1 row_mask:0xf bank_mask:0xf
    v_add_f32_dpp v25, v25, v25 row_ror:1 row_mask:0xf bank_mask:0xf
    s_nop 0
    v_add_f32_dpp v24, v24, v24 row_bcast:15 row_mask:0xa bank_mask:0xf
    v_add_f32_dpp v25, v25, v25 row_bcast:15 row_mask:0xa bank_mask:0xf
    s_nop 0
    v_add_f32_dpp v24, v24, v24 row_bcast:31 row_mask:0xc bank_mask:0xf
    v_add_f32_dpp v25, v25, v25 row_bcast:31 row_mask:0xc bank_mask:0xf
    s_nop 0
    v_readlane_b32 s62, v24, 63
    v_readlane_b32 s63, v25, 63
    s_nop 0
    v_mul_f32 v24, s62, v26
    v_mul_f32 v25, s63, v26
    v_fma_f32 v25, -v24, v24, v25
    v_add_f32 v24, v24, v30
    v_max_f32 v25, 0, v25
    v_cvt_pk_bf16_f32 v24, v24, v25
    v_and_b32 v25, 0xffff0000, v24
    v_lshlrev_b32 v24, 16, v24
    v_add_f32 v25, 0x3727c5ac, v25
    v_sub_f32 v24, v6, v24
    v_cvt_pk_bf16_f32 v24, v24, v25
    v_and_b32 v25, 0xffff0000, v24
    v_sqrt_f32 v25, v25
    v_lshlrev_b32 v24, 16, v24
    v_cvt_pk_bf16_f32 v25, v25, v25
    v_and_b32 v25, 0xffff0000, v25
    v_rcp_f32 v25, v25
    s_nop 0
    v_mul_f32 v24, v24, v25
    v_cvt_pk_bf16_f32 v6, v24, v24
    s_nop 1
    v_and_b32_dpp v16, v6, v2 row_newbcast:0 row_mask:0xf bank_mask:0xf
    v_and_b32_dpp v17, v6, v3 row_newbcast:0 row_mask:0xf bank_mask:0xf
    v_and_b32_dpp v18, v6, v4 row_newbcast:0 row_mask:0xf bank_mask:0xf
    v_and_b32_dpp v19, v6, v5 row_newbcast:0 row_mask:0xf bank_mask:0xf
    s_nop 1
    v_mfma_f32_16x16x32_bf16 v[20:23], v[16:19], v[64:67], 0
    v_and_b32_dpp v16, v6, v2 row_newbcast:1 row_mask:0xf bank_mask:0xf
    v_and_b32_dpp v17, v6, v3 row_newbcast:1 row_mask:0xf bank_mask:0xf
    v_and_b32_dpp v18, v6, v4 row_newbcast:1 row_mask:0xf bank_mask:0xf
    v_and_b32_dpp v19, v6, v5 row_newbcast:1 row_mask:0xf bank_mask:0xf
    s_nop 1
    v_mfma_f32_16x16x32_bf16 v[20:23], v[16:19], v[68:71], v[20:23]
    v_and_b32_dpp v16, v6, v2 row_newbcast:2 row_mask:0xf bank_mask:0xf
    v_and_b32_dpp v17, v6, v3 row_newbcast:2 row_mask:0xf bank_mask:0xf
    v_and_b32_dpp v18, v6, v4 row_newbcast:2 row_mask:0xf bank_mask:0xf
    v_and_b32_dpp v19, v6, v5 row_newbcast:2 row_mask:0xf bank_mask:0xf
    s_nop 1
    v_mfma_f32_16x16x32_bf16 v[20:23], v[16:19], v[72:75], v[20:23]
    v_and_b32_dpp v16, v6, v2 row_newbcast:3 row_mask:0xf bank_mask:0xf
    v_and_b32_dpp v17, v6, v3 row_newbcast:3 row_mask:0xf bank_mask:0xf
    v_and_b32_dpp v18, v6, v4 row_newbcast:3 row_mask:0xf bank_mask:0xf
    v_and_b32_dpp v19, v6, v5 row_newbcast:3 row_mask:0xf bank_mask:0xf
    s_nop 1
    v_mfma_f32_16x16x32_bf16 v[20:23], v[16:19], v[76:79], v[20:23]
    s_waitcnt vmcnt(4)
    s_xor_b32 s66, s54, 0x12000
    buffer_load_dwordx4 v[100:103], v54, s[44:47], s66 offen
    v_and_b32_dpp v16, v6, v2 row_newbcast:4 row_mask:0xf bank_mask:0xf
    v_and_b32_dpp v17, v6, v3 row_newbcast:4 row_mask:0xf bank_mask:0xf
    v_and_b32_dpp v18, v6, v4 row_newbcast:4 row_mask:0xf bank_mask:0xf
    v_and_b32_dpp v19, v6, v5 row_newbcast:4 row_mask:0xf bank_mask:0xf
    s_nop 1
    v_mfma_f32_16x16x32_bf16 v[20:23], v[16:19], v[80:83], v[20:23]
    v_and_b32_dpp v16, v6, v2 row_newbcast:5 row_mask:0xf bank_mask:0xf
    v_and_b32_dpp v17, v6, v3 row_newbcast:5 row_mask:0xf bank_mask:0xf
    v_and_b32_dpp v18, v6, v4 row_newbcast:5 row_mask:0xf bank_mask:0xf
    v_and_b32_dpp v19, v6, v5 row_newbcast:5 row_mask:0xf bank_mask:0xf
    s_nop 1
    v_mfma_f32_16x16x32_bf16 v[20:23], v[16:19], v[84:87], v[20:23]
    v_and_b32_dpp v16, v6, v2 row_newbcast:6 row_mask:0xf bank_mask:0xf
    v_and_b32_dpp v17, v6, v3 row_newbcast:6 row_mask:0xf bank_mask:0xf
    v_and_b32_dpp v18, v6, v4 row_newbcast:6 row_mask:0xf bank_mask:0xf
    v_and_b32_dpp v19, v6, v5 row_newbcast:6 row_mask:0xf bank_mask:0xf
    s_nop 1
    v_mfma_f32_16x16x32_bf16 v[20:23], v[16:19], v[88:91], v[20:23]
    v_and_b32_dpp v16, v6, v2 row_newbcast:7 row_mask:0xf bank_mask:0xf
    v_and_b32_dpp v17, v6, v3 row_newbcast:7 row_mask:0xf bank_mask:0xf
    v_and_b32_dpp v18, v6, v4 row_newbcast:7 row_mask:0xf bank_mask:0xf
    v_and_b32_dpp v19, v6, v5 row_newbcast:7 row_mask:0xf bank_mask:0xf
    s_nop 1
    v_mfma_f32_16x16x32_bf16 v[20:23], v[16:19], v[92:95], v[20:23]
    v_mov_b32 v64, v240
    v_mov_b32 v65, v241
    v_mov_b32 v66, v242
    v_mov_b32 v67, v243
    v_mov_b32 v68, v244
    v_mov_b32 v69, v245
    v_mov_b32 v70, v246
    v_mov_b32 v71, v247
    v_mov_b32 v72, v248
    v_mov_b32 v73, v249
    v_mov_b32 v74, v250
    v_mov_b32 v75, v251
    v_mov_b32 v76, v252
    v_mov_b32 v77, v253
    v_mov_b32 v78, v254
    v_mov_b32 v79, v255
    s_waitcnt vmcnt(4)
    buffer_load_dwordx4 v[204:207], v58, s[36:39], s52 offen offset:2048 nt
    s_add_u32 s52, s52, 0x7000
    s_waitcnt vmcnt(4)
    buffer_load_dwordx4 v[208:211], v58, s[36:39], s52 offen offset:0 nt
    v_and_b32_dpp v16, v6, v2 row_newbcast:8 row_mask:0xf bank_mask:0xf
    v_and_b32_dpp v17, v6, v3 row_newbcast:8 row_mask:0xf bank_mask:0xf
    v_and_b32_dpp v18, v6, v4 row_newbcast:8 row_mask:0xf bank_mask:0xf
    v_and_b32_dpp v19, v6, v5 row_newbcast:8 row_mask:0xf bank_mask:0xf
    s_nop 1
    v_mfma_f32_16x16x32_bf16 v[20:23], v[16:19], v[96:99], v[20:23]
    s_waitcnt vmcnt(4)
    s_xor_b32 s66, s54, 0x14000
    buffer_load_dwordx4 v[104:107], v54, s[44:47], s66 offen
    s_waitcnt vmcnt(4)
    buffer_load_dwordx4 v[212:215], v58, s[36:39], s52 offen offset:2048 nt
    s_add_u32 s52, s52, 0x1000
    s_waitcnt vmcnt(4)
    buffer_load_dwordx4 v[216:219], v58, s[36:39], s52 offen offset:0 nt
    v_and_b32_dpp v16, v6, v2 row_newbcast:9 row_mask:0xf bank_mask:0xf
    v_and_b32_dpp v17, v6, v3 row_newbcast:9 row_mask:0xf bank_mask:0xf
    v_and_b32_dpp v18, v6, v4 row_newbcast:9 row_mask:0xf bank_mask:0xf
    v_and_b32_dpp v19, v6, v5 row_newbcast:9 row_mask:0xf bank_mask:0xf
    s_nop 1
    v_mfma_f32_16x16x32_bf16 v[20:23], v[16:19], v[100:103], v[20:23]
    s_waitcnt vmcnt(4)
    s_xor_b32 s66, s54, 0x16000
    buffer_load_dwordx4 v[108:111], v54, s[44:47], s66 offen
    s_waitcnt vmcnt(4)
    buffer_load_dwordx4 v[220:223], v58, s[36:39], s52 offen offset:2048 nt
    s_add_u32 s52, s52, 0x7000
    s_waitcnt vmcnt(4)
    s_xor_b32 s66, s54, 0x18000
    buffer_load_dwordx4 v[112:115], v54, s[44:47], s66 offen
    v_and_b32_dpp v16, v6, v2 row_newbcast:10 row_mask:0xf bank_mask:0xf
    v_and_b32_dpp v17, v6, v3 row_newbcast:10 row_mask:0xf bank_mask:0xf
    v_and_b32_dpp v18, v6, v4 row_newbcast:10 row_mask:0xf bank_mask:0xf
    v_and_b32_dpp v19, v6, v5 row_newbcast:10 row_mask:0xf bank_mask:0xf
    s_nop 1
    v_mfma_f32_16x16x32_bf16 v[20:23], v[16:19], v[104:107], v[20:23]
    s_waitcnt vmcnt(4)
    buffer_load_dwordx4 v[224:227], v58, s[36:39], s52 offen offset:0 nt
    s_waitcnt vmcnt(4)
    buffer_load_dwordx4 v[228:231], v58, s[36:39], s52 offen offset:2048 nt
    s_add_u32 s52, s52, 0x1000
    s_waitcnt vmcnt(4)
    s_xor_b32 s66, s54, 0x1a000
    buffer_load_dwordx4 v[116:119], v54, s[44:47], s66 offen
    v_and_b32_dpp v16, v6, v2 row_newbcast:11 row_mask:0xf bank_mask:0xf
    v_and_b32_dpp v17, v6, v3 row_newbcast:11 row_mask:0xf bank_mask:0xf
    v_and_b32_dpp v18, v6, v4 row_newbcast:11 row_mask:0xf bank_mask:0xf
    v_and_b32_dpp v19, v6, v5 row_newbcast:11 row_mask:0xf bank_mask:0xf
    s_nop 1
    v_mfma_f32_16x16x32_bf16 v[20:23], v[16:19], v[108:111], v[20:23]
    s_waitcnt vmcnt(4)
    buffer_load_dwordx4 v[232:235], v58, s[36:39], s52 offen offset:0 nt
    s_waitcnt vmcnt(4)
    buffer_load_dwordx4 v[236:239], v58, s[36:39], s52 offen offset:2048 nt
    s_add_u32 s52, s52, 0x7000
    v_and_b32_dpp v16, v6, v2 row_newbcast:12 row_mask:0xf bank_mask:0xf
    v_and_b32_dpp v17, v6, v3 row_newbcast:12 row_mask:0xf bank_mask:0xf
    v_and_b32_dpp v18, v6, v4 row_newbcast:12 row_mask:0xf bank_mask:0xf
    v_and_b32_dpp v19, v6, v5 row_newbcast:12 row_mask:0xf bank_mask:0xf
    s_nop 1
    v_mfma_f32_16x16x32_bf16 v[20:23], v[16:19], v[112:115], v[20:23]
    s_waitcnt vmcnt(4)
    s_xor_b32 s66, s54, 0x1c000
    buffer_load_dwordx4 v[120:123], v54, s[44:47], s66 offen
    s_waitcnt vmcnt(4)
    buffer_load_dwordx4 v[240:243], v58, s[36:39], s52 offen offset:0 nt
    s_waitcnt vmcnt(4)
    buffer_load_dwordx4 v[244:247], v58, s[36:39], s52 offen offset:2048 nt
    s_add_u32 s52, s52, 0x1000
    v_and_b32_dpp v16, v6, v2 row_newbcast:13 row_mask:0xf bank_mask:0xf
    v_and_b32_dpp v17, v6, v3 row_newbcast:13 row_mask:0xf bank_mask:0xf
    v_and_b32_dpp v18, v6, v4 row_newbcast:13 row_mask:0xf bank_mask:0xf
    v_and_b32_dpp v19, v6, v5 row_newbcast:13 row_mask:0xf bank_mask:0xf
    s_nop 1
    v_mfma_f32_16x16x32_bf16 v[20:23], v[16:19], v[116:119], v[20:23]
    s_waitcnt vmcnt(4)
    s_xor_b32 s66, s54, 0x1e000
    buffer_load_dwordx4 v[124:127], v54, s[44:47], s66 offen
    s_waitcnt vmcnt(4)
    buffer_load_dwordx4 v[248:251], v58, s[36:39], s52 offen offset:0 nt
    s_waitcnt vmcnt(4)
    s_xor_b32 s67, s55, 0x1000
    buffer_load_dwordx4 v[80:83], v55, s[48:51], s67 offen
    v_and_b32_dpp v16, v6, v2 row_newbcast:14 row_mask:0xf bank_mask:0xf
    v_and_b32_dpp v17, v6, v3 row_newbcast:14 row_mask:0xf bank_mask:0xf
    v_and_b32_dpp v18, v6, v4 row_newbcast:14 row_mask:0xf bank_mask:0xf
    v_and_b32_dpp v19, v6, v5 row_newbcast:14 row_mask:0xf bank_mask:0xf
    s_nop 1
    v_mfma_f32_16x16x32_bf16 v[20:23], v[16:19], v[120:123], v[20:23]
    s_waitcnt vmcnt(4)
    buffer_load_dwordx4 v[252:255], v58, s[36:39], s52 offen offset:2048 nt
    s_waitcnt vmcnt(4)
    s_lshl_b32 s66, s3, 10
    s_add_u32 m0, s66, 18944
    s_nop 0
    buffer_load_dwordx4 v58, s[40:43], s53 offen offset:0 nt lds
    s_waitcnt vmcnt(4)
    s_xor_b32 s67, s55, 0x1400
    buffer_load_dwordx4 v[84:87], v55, s[48:51], s67 offen
    v_and_b32_dpp v16, v6, v2 row_newbcast:15 row_mask:0xf bank_mask:0xf
    v_and_b32_dpp v17, v6, v3 row_newbcast:15 row_mask:0xf bank_mask:0xf
    v_and_b32_dpp v18, v6, v4 row_newbcast:15 row_mask:0xf bank_mask:0xf
    v_and_b32_dpp v19, v6, v5 row_newbcast:15 row_mask:0xf bank_mask:0xf
    s_nop 1
    v_mfma_f32_16x16x32_bf16 v[20:23], v[16:19], v[124:127], v[20:23]
    s_mov_b32 s44, s20
    s_and_b32 s45, s21, 0xffff
    s_mov_b32 s46, 0x158000
    s_mov_b32 s47, 0x20000
    s_cmp_ge_u32 s1, 22
    s_cselect_b32 s46, 0, s46
    s_nop 1
    ds_write_b128 v46, v[20:23] offset:0
    v_lshlrev_b32 v24, 3, v0
    v_lshlrev_b32 v25, 4, v45
    s_lshl_b32 s6, s3, 8
    v_add_u32 v25, s6, v25
    s_waitcnt lgkmcnt(0)
    s_barrier
    ds_read_b64 v[26:27], v24 offset:0
    ds_read_b64 v[28:29], v24 offset:512
    ds_read_b64 v[30:31], v24 offset:1024
    ds_read_b64 v[32:33], v24 offset:1536
    ds_read_b64 v[34:35], v24 offset:2048
    ds_read_b64 v[36:37], v24 offset:2560
    ds_read_b64 v[38:39], v24 offset:3072
    ds_read_b64 v[40:41], v24 offset:3584
    s_waitcnt vmcnt(4)
    s_lshl_b32 s66, s3, 10
    s_add_u32 m0, s66, 25088
    s_nop 0
    buffer_load_dwordx4 v58, s[40:43], s53 offen offset:2048 nt lds
    s_add_u32 s53, s53, 0x1000
    s_waitcnt lgkmcnt(0)
    v_pk_add_f32 v[26:27], v[26:27], v[28:29]
    v_pk_add_f32 v[30:31], v[30:31], v[32:33]
    v_pk_add_f32 v[34:35], v[34:35], v[36:37]
    v_pk_add_f32 v[38:39], v[38:39], v[40:41]
    v_pk_add_f32 v[26:27], v[26:27], v[30:31]
    v_pk_add_f32 v[34:35], v[34:35], v[38:39]
    v_pk_add_f32 v[26:27], v[26:27], v[34:35]
    v_cvt_pk_bf16_f32 v26, v26, v27
    ds_write_b32 v59, v26 offset:4096
    s_waitcnt lgkmcnt(0)
    ds_read_b128 v[12:15], v25 offset:4096
    s_waitcnt vmcnt(4)
    s_lshl_b32 s66, s3, 10
    s_add_u32 m0, s66, 35328
    s_nop 0
    buffer_load_dwordx4 v58, s[40:43], s53 offen offset:0 nt lds
    s_waitcnt lgkmcnt(0)
    v_dot2_f32_bf16 v24, v128, v12, 0
    v_dot2_f32_bf16 v24, v129, v13, v24
    v_dot2_f32_bf16 v24, v130, v14, v24
    v_dot2_f32_bf16 v24, v131, v15, v24
    v_dot2_f32_bf16 v25, v132, v12, 0
    v_dot2_f32_bf16 v25, v133, v13, v25
    v_dot2_f32_bf16 v25, v134, v14, v25
    v_dot2_f32_bf16 v25, v135, v15, v25
    s_nop 2
    v_add_f32_dpp v24, v24, v24 row_ror:8 row_mask:0xf bank_mask:0x3
    v_add_f32_dpp v24, v25, v25 row_ror:8 row_mask:0xf bank_mask:0xc
    v_dot2_f32_bf16 v26, v136, v12, 0
    v_dot2_f32_bf16 v26, v137, v13, v26
    v_dot2_f32_bf16 v26, v138, v14, v26
    v_dot2_f32_bf16 v26, v139, v15, v26
    v_dot2_f32_bf16 v27, v140, v12, 0
    v_dot2_f32_bf16 v27, v141, v13, v27
    v_dot2_f32_bf16 v27, v142, v14, v27
    v_dot2_f32_bf16 v27, v143, v15, v27
    s_nop 2
    v_add_f32_dpp v26, v26, v26 row_ror:8 row_mask:0xf bank_mask:0x3
    v_add_f32_dpp v26, v27, v27 row_ror:8 row_mask:0xf bank_mask:0xc
    s_nop 1
    v_add_f32_dpp v24, v24, v24 row_half_mirror row_mask:0xf bank_mask:0x5
    v_add_f32_dpp v24, v26, v26 row_half_mirror row_mask:0xf bank_mask:0xa
    s_waitcnt vmcnt(4)
    s_xor_b32 s67, s55, 0x1800
    buffer_load_dwordx4 v[88:91], v55, s[48:51], s67 offen
    v_dot2_f32_bf16 v28, v144, v12, 0
    v_dot2_f32_bf16 v28, v145, v13, v28
    v_dot2_f32_bf16 v28, v146, v14, v28
    v_dot2_f32_bf16 v28, v147, v15, v28
    v_dot2_f32_bf16 v29, v148, v12, 0
    v_dot2_f32_bf16 v29, v149, v13, v29
    v_dot2_f32_bf16 v29, v150, v14, v29
    v_dot2_f32_bf16 v29, v151, v15, v29
    s_nop 2
    v_add_f32_dpp v28, v28, v28 row_ror:8 row_mask:0xf bank_mask:0x3
    v_add_f32_dpp v28, v29, v29 row_ror:8 row_mask:0xf bank_mask:0xc
    v_dot2_f32_bf16 v30, v152, v12, 0
    v_dot2_f32_bf16 v30, v153, v13, v30
    v_dot2_f32_bf16 v30, v154, v14, v30
    v_dot2_f32_bf16 v30, v155, v15, v30
    v_dot2_f32_bf16 v31, v156, v12, 0
    v_dot2_f32_bf16 v31, v157, v13, v31
    v_dot2_f32_bf16 v31, v158, v14, v31
    v_dot2_f32_bf16 v31, v159, v15, v31
    s_nop 2
    v_add_f32_dpp v30, v30, v30 row_ror:8 row_mask:0xf bank_mask:0x3
    v_add_f32_dpp v30, v31, v31 row_ror:8 row_mask:0xf bank_mask:0xc
    s_nop 1
    v_add_f32_dpp v28, v28, v28 row_half_mirror row_mask:0xf bank_mask:0x5
    v_add_f32_dpp v28, v30, v30 row_half_mirror row_mask:0xf bank_mask:0xa
    s_nop 1
    v_add_f32_dpp v24, v24, v24 quad_perm:[2,3,0,1] row_mask:0xf bank_mask:0xf
    v_add_f32_dpp v28, v28, v28 quad_perm:[2,3,0,1] row_mask:0xf bank_mask:0xf
    v_cndmask_b32_e64 v24, v24, v28, s[56:57]
    s_waitcnt vmcnt(4)
    s_lshl_b32 s66, s3, 10
    s_add_u32 m0, s66, 41472
    s_nop 0
    buffer_load_dwordx4 v58, s[40:43], s53 offen offset:2048 nt lds
    s_add_u32 s53, s53, 0x7000
    v_dot2_f32_bf16 v25, v160, v12, 0
    v_dot2_f32_bf16 v25, v161, v13, v25
    v_dot2_f32_bf16 v25, v162, v14, v25
    v_dot2_f32_bf16 v25, v163, v15, v25
    v_dot2_f32_bf16 v27, v164, v12, 0
    v_dot2_f32_bf16 v27, v165, v13, v27
    v_dot2_f32_bf16 v27, v166, v14, v27
    v_dot2_f32_bf16 v27, v167, v15, v27
    s_nop 2
    v_add_f32_dpp v25, v25, v25 row_ror:8 row_mask:0xf bank_mask:0x3
    v_add_f32_dpp v25, v27, v27 row_ror:8 row_mask:0xf bank_mask:0xc
    v_dot2_f32_bf16 v26, v168, v12, 0
    v_dot2_f32_bf16 v26, v169, v13, v26
    v_dot2_f32_bf16 v26, v170, v14, v26
    v_dot2_f32_bf16 v26, v171, v15, v26
    v_dot2_f32_bf16 v29, v172, v12, 0
    v_dot2_f32_bf16 v29, v173, v13, v29
    v_dot2_f32_bf16 v29, v174, v14, v29
    v_dot2_f32_bf16 v29, v175, v15, v29
    s_nop 2
    v_add_f32_dpp v26, v26, v26 row_ror:8 row_mask:0xf bank_mask:0x3
    v_add_f32_dpp v26, v29, v29 row_ror:8 row_mask:0xf bank_mask:0xc
    s_nop 1
    v_add_f32_dpp v25, v25, v25 row_half_mirror row_mask:0xf bank_mask:0x5
    v_add_f32_dpp v25, v26, v26 row_half_mirror row_mask:0xf bank_mask:0xa
    s_waitcnt vmcnt(4)
    s_lshl_b32 s66, s3, 10
    s_add_u32 m0, s66, 51712
    s_nop 0
    buffer_load_dwordx4 v58, s[40:43], s53 offen offset:0 nt lds
    v_dot2_f32_bf16 v31, v176, v12, 0
    v_dot2_f32_bf16 v31, v177, v13, v31
    v_dot2_f32_bf16 v31, v178, v14, v31
    v_dot2_f32_bf16 v31, v179, v15, v31
    v_dot2_f32_bf16 v30, v180, v12, 0
    v_dot2_f32_bf16 v30, v181, v13, v30
    v_dot2_f32_bf16 v30, v182, v14, v30
    v_dot2_f32_bf16 v30, v183, v15, v30
    s_nop 2
    v_add_f32_dpp v31, v31, v31 row_ror:8 row_mask:0xf bank_mask:0x3
    v_add_f32_dpp v31, v30, v30 row_ror:8 row_mask:0xf bank_mask:0xc
    v_dot2_f32_bf16 v28, v184, v12, 0
    v_dot2_f32_bf16 v28, v185, v13, v28
    v_dot2_f32_bf16 v28, v186, v14, v28
    v_dot2_f32_bf16 v28, v187, v15, v28
    v_dot2_f32_bf16 v27, v188, v12, 0
    v_dot2_f32_bf16 v27, v189, v13, v27
    v_dot2_f32_bf16 v27, v190, v14, v27
    v_dot2_f32_bf16 v27, v191, v15, v27
    s_nop 2
    v_add_f32_dpp v28, v28, v28 row_ror:8 row_mask:0xf bank_mask:0x3
    v_add_f32_dpp v28, v27, v27 row_ror:8 row_mask:0xf bank_mask:0xc
    s_nop 1
    v_add_f32_dpp v31, v31, v31 row_half_mirror row_mask:0xf bank_mask:0x5
    v_add_f32_dpp v31, v28, v28 row_half_mirror row_mask:0xf bank_mask:0xa
    s_nop 1
    v_add_f32_dpp v25, v25, v25 quad_perm:[2,3,0,1] row_mask:0xf bank_mask:0xf
    v_add_f32_dpp v31, v31, v31 quad_perm:[2,3,0,1] row_mask:0xf bank_mask:0xf
    v_cndmask_b32_e64 v25, v25, v31, s[56:57]
    s_nop 1
    v_add_f32_dpp v24, v24, v24 quad_perm:[1,0,3,2] row_mask:0xf bank_mask:0xf
    v_add_f32_dpp v25, v25, v25 quad_perm:[1,0,3,2] row_mask:0xf bank_mask:0xf
    v_cndmask_b32_e64 v24, v24, v25, s[58:59]
    v_mov_b32 v60, v24
    s_waitcnt vmcnt(4)
    s_xor_b32 s67, s55, 0x1c00
    buffer_load_dwordx4 v[92:95], v55, s[48:51], s67 offen
    v_dot2_f32_bf16 v29, v192, v12, 0
    v_dot2_f32_bf16 v29, v193, v13, v29
    v_dot2_f32_bf16 v29, v194, v14, v29
    v_dot2_f32_bf16 v29, v195, v15, v29
    v_dot2_f32_bf16 v26, v196, v12, 0
    v_dot2_f32_bf16 v26, v197, v13, v26
    v_dot2_f32_bf16 v26, v198, v14, v26
    v_dot2_f32_bf16 v26, v199, v15, v26
    s_nop 2
    v_add_f32_dpp v29, v29, v29 row_ror:8 row_mask:0xf bank_mask:0x3
    v_add_f32_dpp v29, v26, v26 row_ror:8 row_mask:0xf bank_mask:0xc
    v_dot2_f32_bf16 v30, v200, v12, 0
    v_dot2_f32_bf16 v30, v201, v13, v30
    v_dot2_f32_bf16 v30, v202, v14, v30
    v_dot2_f32_bf16 v30, v203, v15, v30
    v_dot2_f32_bf16 v27, v204, v12, 0
    v_dot2_f32_bf16 v27, v205, v13, v27
    v_dot2_f32_bf16 v27, v206, v14, v27
    v_dot2_f32_bf16 v27, v207, v15, v27
    s_nop 2
    v_add_f32_dpp v30, v30, v30 row_ror:8 row_mask:0xf bank_mask:0x3
    v_add_f32_dpp v30, v27, v27 row_ror:8 row_mask:0xf bank_mask:0xc
    s_nop 1
    v_add_f32_dpp v29, v29, v29 row_half_mirror row_mask:0xf bank_mask:0x5
    v_add_f32_dpp v29, v30, v30 row_half_mirror row_mask:0xf bank_mask:0xa
    s_waitcnt vmcnt(4)
    s_lshl_b32 s66, s3, 10
    s_add_u32 m0, s66, 57856
    s_nop 0
    buffer_load_dwordx4 v58, s[40:43], s53 offen offset:2048 nt lds
    s_add_u32 s53, s53, 0x1000
    v_dot2_f32_bf16 v28, v208, v12, 0
    v_dot2_f32_bf16 v28, v209, v13, v28
    v_dot2_f32_bf16 v28, v210, v14, v28
    v_dot2_f32_bf16 v28, v211, v15, v28
    v_dot2_f32_bf16 v31, v212, v12, 0
    v_dot2_f32_bf16 v31, v213, v13, v31
    v_dot2_f32_bf16 v31, v214, v14, v31
    v_dot2_f32_bf16 v31, v215, v15, v31
    s_nop 2
    v_add_f32_dpp v28, v28, v28 row_ror:8 row_mask:0xf bank_mask:0x3
    v_add_f32_dpp v28, v31, v31 row_ror:8 row_mask:0xf bank_mask:0xc
    v_dot2_f32_bf16 v25, v216, v12, 0
    v_dot2_f32_bf16 v25, v217, v13, v25
    v_dot2_f32_bf16 v25, v218, v14, v25
    v_dot2_f32_bf16 v25, v219, v15, v25
    v_dot2_f32_bf16 v24, v220, v12, 0
    v_dot2_f32_bf16 v24, v221, v13, v24
    v_dot2_f32_bf16 v24, v222, v14, v24
    v_dot2_f32_bf16 v24, v223, v15, v24
    s_nop 2
    v_add_f32_dpp v25, v25, v25 row_ror:8 row_mask:0xf bank_mask:0x3
    v_add_f32_dpp v25, v24, v24 row_ror:8 row_mask:0xf bank_mask:0xc
    s_nop 1
    v_add_f32_dpp v28, v28, v28 row_half_mirror row_mask:0xf bank_mask:0x5
    v_add_f32_dpp v28, v25, v25 row_half_mirror row_mask:0xf bank_mask:0xa
    s_nop 1
    v_add_f32_dpp v29, v29, v29 quad_perm:[2,3,0,1] row_mask:0xf bank_mask:0xf
    v_add_f32_dpp v28, v28, v28 quad_perm:[2,3,0,1] row_mask:0xf bank_mask:0xf
    v_cndmask_b32_e64 v29, v29, v28, s[56:57]
    s_waitcnt vmcnt(4)
    s_xor_b32 s67, s55, 0x10000
    buffer_load_dwordx4 v[96:99], v55, s[48:51], s67 offen
    v_dot2_f32_bf16 v26, v224, v12, 0
    v_dot2_f32_bf16 v26, v225, v13, v26
    v_dot2_f32_bf16 v26, v226, v14, v26
    v_dot2_f32_bf16 v26, v227, v15, v26
    v_dot2_f32_bf16 v27, v228, v12, 0
    v_dot2_f32_bf16 v27, v229, v13, v27
    v_dot2_f32_bf16 v27, v230, v14, v27
    v_dot2_f32_bf16 v27, v231, v15, v27
    s_nop 2
    v_add_f32_dpp v26, v26, v26 row_ror:8 row_mask:0xf bank_mask:0x3
    v_add_f32_dpp v26, v27, v27 row_ror:8 row_mask:0xf bank_mask:0xc
    v_dot2_f32_bf16 v30, v232, v12, 0
    v_dot2_f32_bf16 v30, v233, v13, v30
    v_dot2_f32_bf16 v30, v234, v14, v30
    v_dot2_f32_bf16 v30, v235, v15, v30
    v_dot2_f32_bf16 v31, v236, v12, 0
    v_dot2_f32_bf16 v31, v237, v13, v31
    v_dot2_f32_bf16 v31, v238, v14, v31
    v_dot2_f32_bf16 v31, v239, v15, v31
    s_nop 2
    v_add_f32_dpp v30, v30, v30 row_ror:8 row_mask:0xf bank_mask:0x3
    v_add_f32_dpp v30, v31, v31 row_ror:8 row_mask:0xf bank_mask:0xc
    s_nop 1
    v_add_f32_dpp v26, v26, v26 row_half_mirror row_mask:0xf bank_mask:0x5
    v_add_f32_dpp v26, v30, v30 row_half_mirror row_mask:0xf bank_mask:0xa
    s_waitcnt vmcnt(4)
    buffer_load_dwordx4 v[152:155], v58, s[40:43], s53 offen offset:0 nt
    v_dot2_f32_bf16 v24, v240, v12, 0
    v_dot2_f32_bf16 v24, v241, v13, v24
    v_dot2_f32_bf16 v24, v242, v14, v24
    v_dot2_f32_bf16 v24, v243, v15, v24
    v_dot2_f32_bf16 v25, v244, v12, 0
    v_dot2_f32_bf16 v25, v245, v13, v25
    v_dot2_f32_bf16 v25, v246, v14, v25
    v_dot2_f32_bf16 v25, v247, v15, v25
    s_nop 2
    v_add_f32_dpp v24, v24, v24 row_ror:8 row_mask:0xf bank_mask:0x3
    v_add_f32_dpp v24, v25, v25 row_ror:8 row_mask:0xf bank_mask:0xc
    v_dot2_f32_bf16 v28, v248, v12, 0
    v_dot2_f32_bf16 v28, v249, v13, v28
    v_dot2_f32_bf16 v28, v250, v14, v28
    v_dot2_f32_bf16 v28, v251, v15, v28
    v_dot2_f32_bf16 v27, v252, v12, 0
    v_dot2_f32_bf16 v27, v253, v13, v27
    v_dot2_f32_bf16 v27, v254, v14, v27
    v_dot2_f32_bf16 v27, v255, v15, v27
    s_nop 2
    v_add_f32_dpp v28, v28, v28 row_ror:8 row_mask:0xf bank_mask:0x3
    v_add_f32_dpp v28, v27, v27 row_ror:8 row_mask:0xf bank_mask:0xc
    s_nop 1
    v_add_f32_dpp v24, v24, v24 row_half_mirror row_mask:0xf bank_mask:0x5
    v_add_f32_dpp v24, v28, v28 row_half_mirror row_mask:0xf bank_mask:0xa
    s_nop 1
    v_add_f32_dpp v26, v26, v26 quad_perm:[2,3,0,1] row_mask:0xf bank_mask:0xf
    v_add_f32_dpp v24, v24, v24 quad_perm:[2,3,0,1] row_mask:0xf bank_mask:0xf
    v_cndmask_b32_e64 v26, v26, v24, s[56:57]
    s_nop 1
    v_add_f32_dpp v29, v29, v29 quad_perm:[1,0,3,2] row_mask:0xf bank_mask:0xf
    v_add_f32_dpp v26, v26, v26 quad_perm:[1,0,3,2] row_mask:0xf bank_mask:0xf
    v_cndmask_b32_e64 v29, v29, v26, s[58:59]
    v_mov_b32 v61, v29
    v_cvt_pk_bf16_f32 v61, v60, v61
    v_lshlrev_b32 v60, 16, v61
    v_and_b32 v61, 0xffff0000, v61
    v_mul_f32 v60, 0x3db504f3, v60
    v_mul_f32 v61, 0x3db504f3, v61
    v_cvt_pk_bf16_f32 v61, v60, v61
    v_lshlrev_b32 v60, 16, v61
    v_and_b32 v61, 0xffff0000, v61
    v_max_f32 v26, v60, v61
    s_nop 1
    v_max_f32_dpp v26, v26, v26 row_ror:8 row_mask:0xf bank_mask:0xf
    s_nop 1
    v_max_f32_dpp v26, v26, v26 row_ror:4 row_mask:0xf bank_mask:0xf
    s_nop 1
    v_max_f32_dpp v26, v26, v26 row_ror:2 row_mask:0xf bank_mask:0xf
    s_nop 1
    v_max_f32_dpp v26, v26, v26 row_ror:1 row_mask:0xf bank_mask:0xf
    s_nop 1
    v_max_f32_dpp v26, v26, v26 row_bcast:15 row_mask:0xa bank_mask:0xf
    s_nop 1
    v_max_f32_dpp v26, v26, v26 row_bcast:31 row_mask:0xc bank_mask:0xf
    s_nop 1
    v_readlane_b32 s62, v26, 63
    s_waitcnt vmcnt(4)
    buffer_load_dwordx4 v[156:159], v58, s[40:43], s53 offen offset:2048 nt
    s_add_u32 s53, s53, 0x7000
    s_nop 1
    v_subrev_f32 v24, s62, v60
    v_subrev_f32 v25, s62, v61
    v_mul_f32 v24, 0x3fb8aa3b, v24
    v_mul_f32 v25, 0x3fb8aa3b, v25
    v_exp_f32 v24, v24
    v_exp_f32 v25, v25
    s_nop 0
    v_add_f32 v24, v24, v25
    s_nop 1
    v_add_f32_dpp v24, v24, v24 row_ror:8 row_mask:0xf bank_mask:0xf
    s_nop 1
    v_add_f32_dpp v24, v24, v24 row_ror:4 row_mask:0xf bank_mask:0xf
    s_nop 1
    v_add_f32_dpp v24, v24, v24 row_ror:2 row_mask:0xf bank_mask:0xf
    s_nop 1
    v_add_f32_dpp v24, v24, v24 row_ror:1 row_mask:0xf bank_mask:0xf
    s_nop 1
    v_add_f32_dpp v24, v24, v24 row_bcast:15 row_mask:0xa bank_mask:0xf
    s_nop 1
    v_add_f32_dpp v24, v24, v24 row_bcast:31 row_mask:0xc bank_mask:0xf
    s_nop 1
    v_readlane_b32 s63, v24, 63
    s_lshl_b32 s6, s3, 3
    v_mov_b32 v30, s6
    v_mov_b32 v28, s62
    v_mov_b32 v29, s63
    ds_write_b64 v30, v[28:29] offset:6144
    v_and_b32 v31, 7, v0
    v_lshlrev_b32 v31, 3, v31
    s_waitcnt vmcnt(4)
    s_xor_b32 s67, s55, 0x10400
    buffer_load_dwordx4 v[100:103], v55, s[48:51], s67 offen
    s_waitcnt lgkmcnt(0)
    s_barrier
    ds_read_b64 v[28:29], v31 offset:6144
    s_waitcnt vmcnt(4)
    buffer_load_dwordx4 v[160:163], v58, s[40:43], s53 offen offset:0 nt
    s_waitcnt lgkmcnt(0)
    v_mov_b32 v26, v28
    s_nop 1
    v_max_f32_dpp v26, v26, v26 row_half_mirror row_mask:0xf bank_mask:0xf
    s_nop 1
    v_max_f32_dpp v26, v26, v26 quad_perm:[2,3,0,1] row_mask:0xf bank_mask:0xf
    s_nop 1
    v_max_f32_dpp v26, v26, v26 quad_perm:[1,0,3,2] row_mask:0xf bank_mask:0xf
    s_nop 1
    v_sub_f32 v28, v28, v26
    v_sub_f32 v24, v60, v26
    v_sub_f32 v25, v61, v26
    v_mul_f32 v28, 0x3fb8aa3b, v28
    v_mul_f32 v24, 0x3fb8aa3b, v24
    v_mul_f32 v25, 0x3fb8aa3b, v25
    v_exp_f32 v28, v28
    v_exp_f32 v24, v24
    v_exp_f32 v25, v25
    v_mul_f32 v28, v28, v29
    s_nop 1
    v_add_f32_dpp v28, v28, v28 row_half_mirror row_mask:0xf bank_mask:0xf
    s_nop 1
    v_add_f32_dpp v28, v28, v28 quad_perm:[2,3,0,1] row_mask:0xf bank_mask:0xf
    s_nop 1
    v_add_f32_dpp v28, v28, v28 quad_perm:[1,0,3,2] row_mask:0xf bank_mask:0xf
    s_nop 1
    v_rcp_f32 v28, v28
    s_nop 0
    v_mul_f32 v24, v24, v28
    v_mul_f32 v25, v25, v28
    v_cvt_pk_bf16_f32 v6, v24, v24
    v_cvt_pk_bf16_f32 v7, v25, v25
    s_waitcnt vmcnt(4)
    buffer_load_dwordx4 v[164:167], v58, s[40:43], s53 offen offset:2048 nt
    s_add_u32 s53, s53, 0x1000
    s_and_b32 s7, s0, 0x18
    s_lshl_b32 s7, s7, 1
    v_xor_b32 v54, s7, v1
    s_mov_b32 s56, 0x05040100
    s_mov_b32 s57, 0x07060302
    v_and_b32 v32, 3, v0
    s_mov_b32 s68, 0x88888888
    s_mov_b32 s69, 0x88888888
    v_mov_b32 v33, 0xffff
    v_mov_b32 v34, 0xffff0000
    v_cndmask_b32_e64 v33, v33, v34, s[68:69]
    v_cndmask_b32_e64 v32, v32, 0, s[68:69]
    v_or_b32 v32, 12, v32
    v_mul_u32_u24 v39, 0x1111, v32
    s_mov_b32 s68, 0xff00ff00
    s_mov_b32 s69, 0xff00ff00
    v_cndmask_b32_e64 v36, v33, 0, s[68:69]
    v_cndmask_b32_e64 v37, 0, v33, s[68:69]
    v_mov_b32 v32, 0x4444
    v_mov_b32 v33, 0xeeee
    v_cndmask_b32_e64 v38, v32, v33, s[68:69]
    s_mov_b32 s68, 0xf0f0f0f0
    s_mov_b32 s69, 0xf0f0f0f0
    v_cndmask_b32_e64 v59, v32, v33, s[68:69]
    v_and_b32 v12, 0x3f803f80, v36
    v_and_b32 v13, 0x3f803f80, v37
    v_and_b32 v14, 0x3f803f80, v36
    v_and_b32 v15, 0x3f803f80, v37
    v_mov_b32 v60, 0x3f803f80
    v_mov_b32 v61, 0x3f803f80
    v_mov_b32 v62, 0x3f803f80
    v_mov_b32 v63, 0x3f803f80
    s_lshl_b32 s6, s4, 5
    s_lshl_b32 s66, s3, 10
    v_add_u32 v24, s66, v1
    ds_read_b128 v[128:131], v24 offset:18944
    ds_read_b128 v[132:135], v24 offset:27136
    ds_read_b128 v[136:139], v24 offset:35328
    ds_read_b128 v[140:143], v24 offset:43520
    ds_read_b128 v[144:147], v24 offset:51712
    v_add_u32 v24, 0xa000, v24
    ds_read_b128 v[148:151], v24 offset:18944
    s_waitcnt lgkmcnt(0)
    v_and_b32_dpp v16, v6, v2 row_newbcast:0 row_mask:0xf bank_mask:0xf
    v_and_b32_dpp v17, v6, v3 row_newbcast:0 row_mask:0xf bank_mask:0xf
    v_and_b32_dpp v18, v6, v4 row_newbcast:0 row_mask:0xf bank_mask:0xf
    v_and_b32_dpp v19, v6, v5 row_newbcast:0 row_mask:0xf bank_mask:0xf
    s_nop 1
    v_mfma_f32_16x16x32_bf16 v[20:23], v[16:19], v[128:131], 0
    v_and_b32_dpp v16, v6, v2 row_newbcast:8 row_mask:0xf bank_mask:0xf
    v_and_b32_dpp v17, v6, v3 row_newbcast:8 row_mask:0xf bank_mask:0xf
    v_and_b32_dpp v18, v6, v4 row_newbcast:8 row_mask:0xf bank_mask:0xf
    v_and_b32_dpp v19, v6, v5 row_newbcast:8 row_mask:0xf bank_mask:0xf
    s_nop 1
    v_mfma_f32_16x16x32_bf16 v[20:23], v[16:19], v[132:135], v[20:23]
    v_and_b32_dpp v16, v6, v2 row_newbcast:4 row_mask:0xf bank_mask:0xf
    v_and_b32_dpp v17, v6, v3 row_newbcast:4 row_mask:0xf bank_mask:0xf
    v_and_b32_dpp v18, v6, v4 row_newbcast:4 row_mask:0xf bank_mask:0xf
    v_and_b32_dpp v19, v6, v5 row_newbcast:4 row_mask:0xf bank_mask:0xf
    s_nop 1
    v_mfma_f32_16x16x32_bf16 v[20:23], v[16:19], v[136:139], v[20:23]
    v_and_b32_dpp v16, v6, v2 row_newbcast:12 row_mask:0xf bank_mask:0xf
    v_and_b32_dpp v17, v6, v3 row_newbcast:12 row_mask:0xf bank_mask:0xf
    v_and_b32_dpp v18, v6, v4 row_newbcast:12 row_mask:0xf bank_mask:0xf
    v_and_b32_dpp v19, v6, v5 row_newbcast:12 row_mask:0xf bank_mask:0xf
    s_nop 1
    v_mfma_f32_16x16x32_bf16 v[20:23], v[16:19], v[140:143], v[20:23]
    v_perm_b32 v192, v68, v64, s56
    v_perm_b32 v193, v76, v72, s56
    v_perm_b32 v194, v84, v80, s56
    v_perm_b32 v195, v92, v88, s56
    v_perm_b32 v200, v68, v64, s57
    v_perm_b32 v201, v76, v72, s57
    v_perm_b32 v202, v84, v80, s57
    v_perm_b32 v203, v92, v88, s57
    v_perm_b32 v208, v69, v65, s56
    v_perm_b32 v209, v77, v73, s56
    v_perm_b32 v210, v85, v81, s56
    v_perm_b32 v211, v93, v89, s56
    v_perm_b32 v216, v69, v65, s57
    v_perm_b32 v217, v77, v73, s57
    v_perm_b32 v218, v85, v81, s57
    v_perm_b32 v219, v93, v89, s57
    v_perm_b32 v224, v70, v66, s56
    v_perm_b32 v225, v78, v74, s56
    v_perm_b32 v226, v86, v82, s56
    v_perm_b32 v227, v94, v90, s56
    v_perm_b32 v232, v70, v66, s57
    v_perm_b32 v233, v78, v74, s57
    v_perm_b32 v234, v86, v82, s57
    v_perm_b32 v235, v94, v90, s57
    v_perm_b32 v240, v71, v67, s56
    v_perm_b32 v241, v79, v75, s56
    v_perm_b32 v242, v87, v83, s56
    v_perm_b32 v243, v95, v91, s56
    v_perm_b32 v248, v71, v67, s57
    v_perm_b32 v249, v79, v75, s57
    v_perm_b32 v250, v87, v83, s57
    v_perm_b32 v251, v95, v91, s57
    s_waitcnt vmcnt(4)
    s_xor_b32 s67, s55, 0x10800
    buffer_load_dwordx4 v[104:107], v55, s[48:51], s67 offen
    v_and_b32_dpp v16, v6, v2 row_newbcast:2 row_mask:0xf bank_mask:0xf
    v_and_b32_dpp v17, v6, v3 row_newbcast:2 row_mask:0xf bank_mask:0xf
    v_and_b32_dpp v18, v6, v4 row_newbcast:2 row_mask:0xf bank_mask:0xf
    v_and_b32_dpp v19, v6, v5 row_newbcast:2 row_mask:0xf bank_mask:0xf
    s_nop 1
    v_mfma_f32_16x16x32_bf16 v[20:23], v[16:19], v[144:147], v[20:23]
    v_and_b32_dpp v16, v6, v2 row_newbcast:10 row_mask:0xf bank_mask:0xf
    v_and_b32_dpp v17, v6, v3 row_newbcast:10 row_mask:0xf bank_mask:0xf
    v_and_b32_dpp v18, v6, v4 row_newbcast:10 row_mask:0xf bank_mask:0xf
    v_and_b32_dpp v19, v6, v5 row_newbcast:10 row_mask:0xf bank_mask:0xf
    s_nop 1
    v_mfma_f32_16x16x32_bf16 v[20:23], v[16:19], v[148:151], v[20:23]
    v_and_b32_dpp v16, v6, v2 row_newbcast:6 row_mask:0xf bank_mask:0xf
    v_and_b32_dpp v17, v6, v3 row_newbcast:6 row_mask:0xf bank_mask:0xf
    v_and_b32_dpp v18, v6, v4 row_newbcast:6 row_mask:0xf bank_mask:0xf
    v_and_b32_dpp v19, v6, v5 row_newbcast:6 row_mask:0xf bank_mask:0xf
    s_nop 1
    v_mfma_f32_16x16x32_bf16 v[20:23], v[16:19], v[152:155], v[20:23]
    s_waitcnt vmcnt(4)
    buffer_load_dwordx4 v[168:171], v58, s[40:43], s53 offen offset:0 nt
    v_and_b32_dpp v16, v6, v2 row_newbcast:14 row_mask:0xf bank_mask:0xf
    v_and_b32_dpp v17, v6, v3 row_newbcast:14 row_mask:0xf bank_mask:0xf
    v_and_b32_dpp v18, v6, v4 row_newbcast:14 row_mask:0xf bank_mask:0xf
    v_and_b32_dpp v19, v6, v5 row_newbcast:14 row_mask:0xf bank_mask:0xf
    s_nop 1
    v_mfma_f32_16x16x32_bf16 v[20:23], v[16:19], v[156:159], v[20:23]
    s_waitcnt vmcnt(4)
    buffer_load_dwordx4 v[172:175], v58, s[40:43], s53 offen offset:2048 nt
    s_add_u32 s53, s53, 0x7000
    s_waitcnt vmcnt(4)
    s_xor_b32 s67, s55, 0x10c00
    buffer_load_dwordx4 v[108:111], v55, s[48:51], s67 offen
    v_and_b32_dpp v16, v6, v2 row_newbcast:1 row_mask:0xf bank_mask:0xf
    v_and_b32_dpp v17, v6, v3 row_newbcast:1 row_mask:0xf bank_mask:0xf
    v_and_b32_dpp v18, v6, v4 row_newbcast:1 row_mask:0xf bank_mask:0xf
    v_and_b32_dpp v19, v6, v5 row_newbcast:1 row_mask:0xf bank_mask:0xf
    s_nop 1
    v_mfma_f32_16x16x32_bf16 v[20:23], v[16:19], v[160:163], v[20:23]
    s_waitcnt vmcnt(4)
    buffer_load_dwordx4 v[176:179], v58, s[40:43], s53 offen offset:0 nt
    v_and_b32_dpp v16, v6, v2 row_newbcast:9 row_mask:0xf bank_mask:0xf
    v_and_b32_dpp v17, v6, v3 row_newbcast:9 row_mask:0xf bank_mask:0xf
    v_and_b32_dpp v18, v6, v4 row_newbcast:9 row_mask:0xf bank_mask:0xf
    v_and_b32_dpp v19, v6, v5 row_newbcast:9 row_mask:0xf bank_mask:0xf
    s_nop 1
    v_mfma_f32_16x16x32_bf16 v[20:23], v[16:19], v[164:167], v[20:23]
    s_waitcnt vmcnt(4)
    s_xor_b32 s67, s55, 0x11000
    buffer_load_dwordx4 v[112:115], v55, s[48:51], s67 offen
    s_waitcnt vmcnt(4)
    buffer_load_dwordx4 v[180:183], v58, s[40:43], s53 offen offset:2048 nt
    s_add_u32 s53, s53, 0x1000
    v_and_b32_dpp v16, v6, v2 row_newbcast:5 row_mask:0xf bank_mask:0xf
    v_and_b32_dpp v17, v6, v3 row_newbcast:5 row_mask:0xf bank_mask:0xf
    v_and_b32_dpp v18, v6, v4 row_newbcast:5 row_mask:0xf bank_mask:0xf
    v_and_b32_dpp v19, v6, v5 row_newbcast:5 row_mask:0xf bank_mask:0xf
    s_nop 1
    v_mfma_f32_16x16x32_bf16 v[20:23], v[16:19], v[168:171], v[20:23]
    s_waitcnt vmcnt(4)
    buffer_load_dwordx4 v[184:187], v58, s[40:43], s53 offen offset:0 nt
    v_and_b32_dpp v16, v6, v2 row_newbcast:13 row_mask:0xf bank_mask:0xf
    v_and_b32_dpp v17, v6, v3 row_newbcast:13 row_mask:0xf bank_mask:0xf
    v_and_b32_dpp v18, v6, v4 row_newbcast:13 row_mask:0xf bank_mask:0xf
    v_and_b32_dpp v19, v6, v5 row_newbcast:13 row_mask:0xf bank_mask:0xf
    s_nop 1
    v_mfma_f32_16x16x32_bf16 v[20:23], v[16:19], v[172:175], v[20:23]
    s_waitcnt vmcnt(4)
    s_xor_b32 s67, s55, 0x11400
    buffer_load_dwordx4 v[116:119], v55, s[48:51], s67 offen
    s_waitcnt vmcnt(4)
    buffer_load_dwordx4 v[188:191], v58, s[40:43], s53 offen offset:2048 nt
    s_add_u32 s53, s53, 0x7000
    v_and_b32_dpp v16, v6, v2 row_newbcast:3 row_mask:0xf bank_mask:0xf
    v_and_b32_dpp v17, v6, v3 row_newbcast:3 row_mask:0xf bank_mask:0xf
    v_and_b32_dpp v18, v6, v4 row_newbcast:3 row_mask:0xf bank_mask:0xf
    v_and_b32_dpp v19, v6, v5 row_newbcast:3 row_mask:0xf bank_mask:0xf
    s_nop 1
    v_mfma_f32_16x16x32_bf16 v[20:23], v[16:19], v[176:179], v[20:23]
    s_waitcnt vmcnt(4)
    buffer_load_dwordx4 v[128:131], v58, s[40:43], s53 offen offset:0 nt
    s_waitcnt vmcnt(4)
    s_xor_b32 s67, s55, 0x11800
    buffer_load_dwordx4 v[120:123], v55, s[48:51], s67 offen
    v_and_b32_dpp v16, v6, v2 row_newbcast:11 row_mask:0xf bank_mask:0xf
    v_and_b32_dpp v17, v6, v3 row_newbcast:11 row_mask:0xf bank_mask:0xf
    v_and_b32_dpp v18, v6, v4 row_newbcast:11 row_mask:0xf bank_mask:0xf
    v_and_b32_dpp v19, v6, v5 row_newbcast:11 row_mask:0xf bank_mask:0xf
    s_nop 1
    v_mfma_f32_16x16x32_bf16 v[20:23], v[16:19], v[180:183], v[20:23]
    s_waitcnt vmcnt(4)
    buffer_load_dwordx4 v[132:135], v58, s[40:43], s53 offen offset:2048 nt
    s_add_u32 s53, s53, 0x1000
    v_and_b32_dpp v16, v6, v2 row_newbcast:7 row_mask:0xf bank_mask:0xf
    v_and_b32_dpp v17, v6, v3 row_newbcast:7 row_mask:0xf bank_mask:0xf
    v_and_b32_dpp v18, v6, v4 row_newbcast:7 row_mask:0xf bank_mask:0xf
    v_and_b32_dpp v19, v6, v5 row_newbcast:7 row_mask:0xf bank_mask:0xf
    s_nop 1
    v_mfma_f32_16x16x32_bf16 v[20:23], v[16:19], v[184:187], v[20:23]
    s_waitcnt vmcnt(4)
    buffer_load_dwordx4 v[136:139], v58, s[40:43], s53 offen offset:0 nt
    s_waitcnt vmcnt(4)
    s_xor_b32 s67, s55, 0x11c00
    buffer_load_dwordx4 v[124:127], v55, s[48:51], s67 offen
    v_and_b32_dpp v16, v6, v2 row_newbcast:15 row_mask:0xf bank_mask:0xf
    v_and_b32_dpp v17, v6, v3 row_newbcast:15 row_mask:0xf bank_mask:0xf
    v_and_b32_dpp v18, v6, v4 row_newbcast:15 row_mask:0xf bank_mask:0xf
    v_and_b32_dpp v19, v6, v5 row_newbcast:15 row_mask:0xf bank_mask:0xf
    s_nop 1
    v_mfma_f32_16x16x32_bf16 v[20:23], v[16:19], v[188:191], v[20:23]
    s_load_dword s71, s[30:31], s6
    s_waitcnt vmcnt(4)
    buffer_load_dwordx4 v[140:143], v58, s[40:43], s53 offen offset:2048 nt
    s_add_u32 s53, s53, 0x7000
    v_and_b32_dpp v16, v7, v2 row_newbcast:0 row_mask:0xf bank_mask:0xf
    v_and_b32_dpp v17, v7, v3 row_newbcast:0 row_mask:0xf bank_mask:0xf
    v_and_b32_dpp v18, v7, v4 row_newbcast:0 row_mask:0xf bank_mask:0xf
    v_and_b32_dpp v19, v7, v5 row_newbcast:0 row_mask:0xf bank_mask:0xf
    s_nop 1
    v_mfma_f32_16x16x32_bf16 v[20:23], v[16:19], v[128:131], v[20:23]
    s_waitcnt vmcnt(4)
    s_add_u32 s7, s10, 0
    buffer_load_dwordx2 v[64:65], v56, s[44:47], s7 offen
    buffer_load_dwordx2 v[66:67], v56, s[44:47], s7 offen offset:2752
    s_waitcnt vmcnt(5)
    buffer_load_dwordx4 v[144:147], v58, s[40:43], s53 offen offset:0 nt
    v_and_b32_dpp v16, v7, v2 row_newbcast:8 row_mask:0xf bank_mask:0xf
    v_and_b32_dpp v17, v7, v3 row_newbcast:8 row_mask:0xf bank_mask:0xf
    v_and_b32_dpp v18, v7, v4 row_newbcast:8 row_mask:0xf bank_mask:0xf
    v_and_b32_dpp v19, v7, v5 row_newbcast:8 row_mask:0xf bank_mask:0xf
    s_nop 1
    v_mfma_f32_16x16x32_bf16 v[20:23], v[16:19], v[132:135], v[20:23]
    s_waitcnt vmcnt(5)
    buffer_load_dwordx4 v[148:151], v58, s[40:43], s53 offen offset:2048 nt
    s_add_u32 s53, s53, 0x1000
    v_and_b32_dpp v16, v7, v2 row_newbcast:4 row_mask:0xf bank_mask:0xf
    v_and_b32_dpp v17, v7, v3 row_newbcast:4 row_mask:0xf bank_mask:0xf
    v_and_b32_dpp v18, v7, v4 row_newbcast:4 row_mask:0xf bank_mask:0xf
    v_and_b32_dpp v19, v7, v5 row_newbcast:4 row_mask:0xf bank_mask:0xf
    s_nop 1
    v_mfma_f32_16x16x32_bf16 v[20:23], v[16:19], v[136:139], v[20:23]
    s_waitcnt vmcnt(5)
    buffer_load_dwordx4 v[152:155], v58, s[40:43], s53 offen offset:0 nt
    v_perm_b32 v196, v100, v96, s56
    v_perm_b32 v197, v108, v104, s56
    v_perm_b32 v198, v116, v112, s56
    v_perm_b32 v199, v124, v120, s56
    v_perm_b32 v204, v100, v96, s57
    v_perm_b32 v205, v108, v104, s57
    v_perm_b32 v206, v116, v112, s57
    v_perm_b32 v207, v124, v120, s57
    v_perm_b32 v212, v101, v97, s56
    v_perm_b32 v213, v109, v105, s56
    v_perm_b32 v214, v117, v113, s56
    v_perm_b32 v215, v125, v121, s56
    v_perm_b32 v220, v101, v97, s57
    v_perm_b32 v221, v109, v105, s57
    v_perm_b32 v222, v117, v113, s57
    v_perm_b32 v223, v125, v121, s57
    v_perm_b32 v228, v102, v98, s56
    v_perm_b32 v229, v110, v106, s56
    v_perm_b32 v230, v118, v114, s56
    v_perm_b32 v231, v126, v122, s56
    v_perm_b32 v236, v102, v98, s57
    v_perm_b32 v237, v110, v106, s57
    v_perm_b32 v238, v118, v114, s57
    v_perm_b32 v239, v126, v122, s57
    v_perm_b32 v244, v103, v99, s56
    v_perm_b32 v245, v111, v107, s56
    v_perm_b32 v246, v119, v115, s56
    v_perm_b32 v247, v127, v123, s56
    v_perm_b32 v252, v103, v99, s57
    v_perm_b32 v253, v111, v107, s57
    v_perm_b32 v254, v119, v115, s57
    v_perm_b32 v255, v127, v123, s57
    s_waitcnt vmcnt(5)
    s_add_u32 s7, s10, 88064
    buffer_load_dwordx2 v[68:69], v56, s[44:47], s7 offen
    buffer_load_dwordx2 v[70:71], v56, s[44:47], s7 offen offset:2752
    v_and_b32_dpp v16, v7, v2 row_newbcast:12 row_mask:0xf bank_mask:0xf
    v_and_b32_dpp v17, v7, v3 row_newbcast:12 row_mask:0xf bank_mask:0xf
    v_and_b32_dpp v18, v7, v4 row_newbcast:12 row_mask:0xf bank_mask:0xf
    v_and_b32_dpp v19, v7, v5 row_newbcast:12 row_mask:0xf bank_mask:0xf
    s_nop 1
    v_mfma_f32_16x16x32_bf16 v[20:23], v[16:19], v[140:143], v[20:23]
    s_waitcnt vmcnt(5)
    buffer_load_dwordx4 v[156:159], v58, s[40:43], s53 offen offset:2048 nt
    s_add_u32 s53, s53, 0x7000
    s_waitcnt vmcnt(5)
    buffer_load_dwordx4 v[160:163], v58, s[40:43], s53 offen offset:0 nt
    v_and_b32_dpp v16, v7, v2 row_newbcast:2 row_mask:0xf bank_mask:0xf
    v_and_b32_dpp v17, v7, v3 row_newbcast:2 row_mask:0xf bank_mask:0xf
    v_and_b32_dpp v18, v7, v4 row_newbcast:2 row_mask:0xf bank_mask:0xf
    v_and_b32_dpp v19, v7, v5 row_newbcast:2 row_mask:0xf bank_mask:0xf
    s_nop 1
    v_mfma_f32_16x16x32_bf16 v[20:23], v[16:19], v[144:147], v[20:23]
    s_waitcnt vmcnt(5)
    buffer_load_dwordx4 v[164:167], v58, s[40:43], s53 offen offset:2048 nt
    s_add_u32 s53, s53, 0x1000
    v_and_b32_dpp v16, v7, v2 row_newbcast:10 row_mask:0xf bank_mask:0xf
    v_and_b32_dpp v17, v7, v3 row_newbcast:10 row_mask:0xf bank_mask:0xf
    v_and_b32_dpp v18, v7, v4 row_newbcast:10 row_mask:0xf bank_mask:0xf
    v_and_b32_dpp v19, v7, v5 row_newbcast:10 row_mask:0xf bank_mask:0xf
    s_nop 1
    v_mfma_f32_16x16x32_bf16 v[20:23], v[16:19], v[148:151], v[20:23]
    s_waitcnt vmcnt(5)
    s_add_u32 s7, s10, 22016
    buffer_load_dwordx2 v[72:73], v56, s[44:47], s7 offen
    buffer_load_dwordx2 v[74:75], v56, s[44:47], s7 offen offset:2752
    v_and_b32_dpp v16, v7, v2 row_newbcast:6 row_mask:0xf bank_mask:0xf
    v_and_b32_dpp v17, v7, v3 row_newbcast:6 row_mask:0xf bank_mask:0xf
    v_and_b32_dpp v18, v7, v4 row_newbcast:6 row_mask:0xf bank_mask:0xf
    v_and_b32_dpp v19, v7, v5 row_newbcast:6 row_mask:0xf bank_mask:0xf
    s_nop 1
    v_mfma_f32_16x16x32_bf16 v[20:23], v[16:19], v[152:155], v[20:23]
    s_waitcnt vmcnt(5)
    buffer_load_dwordx4 v[168:171], v58, s[40:43], s53 offen offset:0 nt
    s_waitcnt vmcnt(5)
    buffer_load_dwordx4 v[172:175], v58, s[40:43], s53 offen offset:2048 nt
    s_add_u32 s53, s53, 0x7000
    v_and_b32_dpp v16, v7, v2 row_newbcast:14 row_mask:0xf bank_mask:0xf
    v_and_b32_dpp v17, v7, v3 row_newbcast:14 row_mask:0xf bank_mask:0xf
    v_and_b32_dpp v18, v7, v4 row_newbcast:14 row_mask:0xf bank_mask:0xf
    v_and_b32_dpp v19, v7, v5 row_newbcast:14 row_mask:0xf bank_mask:0xf
    s_nop 1
    v_mfma_f32_16x16x32_bf16 v[20:23], v[16:19], v[156:159], v[20:23]
    s_waitcnt vmcnt(5)
    buffer_load_dwordx4 v[176:179], v58, s[40:43], s53 offen offset:0 nt
    v_and_b32_dpp v16, v7, v2 row_newbcast:1 row_mask:0xf bank_mask:0xf
    v_and_b32_dpp v17, v7, v3 row_newbcast:1 row_mask:0xf bank_mask:0xf
    v_and_b32_dpp v18, v7, v4 row_newbcast:1 row_mask:0xf bank_mask:0xf
    v_and_b32_dpp v19, v7, v5 row_newbcast:1 row_mask:0xf bank_mask:0xf
    s_nop 1
    v_mfma_f32_16x16x32_bf16 v[20:23], v[16:19], v[160:163], v[20:23]
    v_mov_b32 v128, 0
    v_mov_b32 v132, 0
    v_mov_b32 v136, 0
    v_mov_b32 v140, 0
    v_mov_b32 v144, 0
    v_mov_b32 v148, 0
    v_mov_b32 v152, 0
    v_mov_b32 v156, 0
    s_waitcnt vmcnt(5)
    buffer_load_dwordx4 v[180:183], v58, s[40:43], s53 offen offset:2048 nt
    s_add_u32 s53, s53, 0x1000
    v_and_b32_dpp v16, v7, v2 row_newbcast:9 row_mask:0xf bank_mask:0xf
    v_and_b32_dpp v17, v7, v3 row_newbcast:9 row_mask:0xf bank_mask:0xf
    v_and_b32_dpp v18, v7, v4 row_newbcast:9 row_mask:0xf bank_mask:0xf
    v_and_b32_dpp v19, v7, v5 row_newbcast:9 row_mask:0xf bank_mask:0xf
    s_nop 1
    v_mfma_f32_16x16x32_bf16 v[20:23], v[16:19], v[164:167], v[20:23]
    s_waitcnt vmcnt(4)
    buffer_load_dwordx4 v[184:187], v58, s[40:43], s53 offen offset:0 nt
    s_waitcnt vmcnt(4)
    buffer_load_dwordx4 v[188:191], v58, s[40:43], s53 offen offset:2048 nt
    s_barrier
    v_and_b32_dpp v16, v7, v2 row_newbcast:5 row_mask:0xf bank_mask:0xf
    v_and_b32_dpp v17, v7, v3 row_newbcast:5 row_mask:0xf bank_mask:0xf
    v_and_b32_dpp v18, v7, v4 row_newbcast:5 row_mask:0xf bank_mask:0xf
    v_and_b32_dpp v19, v7, v5 row_newbcast:5 row_mask:0xf bank_mask:0xf
    s_nop 1
    v_mfma_f32_16x16x32_bf16 v[20:23], v[16:19], v[168:171], v[20:23]
    v_and_b32_dpp v16, v7, v2 row_newbcast:13 row_mask:0xf bank_mask:0xf
    v_and_b32_dpp v17, v7, v3 row_newbcast:13 row_mask:0xf bank_mask:0xf
    v_and_b32_dpp v18, v7, v4 row_newbcast:13 row_mask:0xf bank_mask:0xf
    v_and_b32_dpp v19, v7, v5 row_newbcast:13 row_mask:0xf bank_mask:0xf
    s_waitcnt vmcnt(4)
    s_nop 0
    v_mfma_f32_16x16x32_bf16 v[20:23], v[16:19], v[172:175], v[20:23]
    s_add_u32 s7, s10, 110080
    buffer_load_dwordx2 v[76:77], v56, s[44:47], s7 offen
    buffer_load_dwordx2 v[78:79], v56, s[44:47], s7 offen offset:2752
    v_and_b32_dpp v16, v7, v2 row_newbcast:3 row_mask:0xf bank_mask:0xf
    v_and_b32_dpp v17, v7, v3 row_newbcast:3 row_mask:0xf bank_mask:0xf
    v_and_b32_dpp v18, v7, v4 row_newbcast:3 row_mask:0xf bank_mask:0xf
    v_and_b32_dpp v19, v7, v5 row_newbcast:3 row_mask:0xf bank_mask:0xf
    s_waitcnt vmcnt(5)
    s_nop 0
    v_mfma_f32_16x16x32_bf16 v[20:23], v[16:19], v[176:179], v[20:23]
    s_add_u32 s7, s10, 11008
    buffer_load_dwordx2 v[80:81], v56, s[44:47], s7 offen
    buffer_load_dwordx2 v[82:83], v56, s[44:47], s7 offen offset:2752
    v_and_b32_dpp v16, v7, v2 row_newbcast:11 row_mask:0xf bank_mask:0xf
    v_and_b32_dpp v17, v7, v3 row_newbcast:11 row_mask:0xf bank_mask:0xf
    v_and_b32_dpp v18, v7, v4 row_newbcast:11 row_mask:0xf bank_mask:0xf
    v_and_b32_dpp v19, v7, v5 row_newbcast:11 row_mask:0xf bank_mask:0xf
    s_waitcnt vmcnt(6)
    s_nop 0
    v_mfma_f32_16x16x32_bf16 v[20:23], v[16:19], v[180:183], v[20:23]
    s_add_u32 s7, s10, 99072
    buffer_load_dwordx2 v[84:85], v56, s[44:47], s7 offen
    buffer_load_dwordx2 v[86:87], v56, s[44:47], s7 offen offset:2752
    v_and_b32_dpp v16, v7, v2 row_newbcast:7 row_mask:0xf bank_mask:0xf
    v_and_b32_dpp v17, v7, v3 row_newbcast:7 row_mask:0xf bank_mask:0xf
    v_and_b32_dpp v18, v7, v4 row_newbcast:7 row_mask:0xf bank_mask:0xf
    v_and_b32_dpp v19, v7, v5 row_newbcast:7 row_mask:0xf bank_mask:0xf
    s_waitcnt vmcnt(7)
    s_nop 0
    v_mfma_f32_16x16x32_bf16 v[20:23], v[16:19], v[184:187], v[20:23]
    s_add_u32 s7, s10, 33024
    buffer_load_dwordx2 v[88:89], v56, s[44:47], s7 offen
    buffer_load_dwordx2 v[90:91], v56, s[44:47], s7 offen offset:2752
    v_and_b32_dpp v16, v7, v2 row_newbcast:15 row_mask:0xf bank_mask:0xf
    v_and_b32_dpp v17, v7, v3 row_newbcast:15 row_mask:0xf bank_mask:0xf
    v_and_b32_dpp v18, v7, v4 row_newbcast:15 row_mask:0xf bank_mask:0xf
    v_and_b32_dpp v19, v7, v5 row_newbcast:15 row_mask:0xf bank_mask:0xf
    s_waitcnt vmcnt(8)
    s_nop 0
    v_mfma_f32_16x16x32_bf16 v[20:23], v[16:19], v[188:191], v[20:23]
L_tail:
    s_nop 7
    ds_write_b128 v46, v[20:23] offset:6272
    s_waitcnt lgkmcnt(0)
    s_barrier
    ds_read_b64 v[160:161], v47 offset:0
    ds_read_b64 v[162:163], v47 offset:512
    ds_read_b64 v[164:165], v47 offset:1024
    ds_read_b64 v[166:167], v47 offset:1536
    ds_read_b64 v[168:169], v47 offset:2048
    ds_read_b64 v[170:171], v47 offset:2560
    ds_read_b64 v[172:173], v47 offset:3072
    ds_read_b64 v[174:175], v47 offset:3584
    s_waitcnt lgkmcnt(6)
    v_pk_add_f32 v[160:161], v[160:161], v[162:163]
    s_waitcnt lgkmcnt(4)
    v_pk_add_f32 v[164:165], v[164:165], v[166:167]
    s_waitcnt lgkmcnt(2)
    v_pk_add_f32 v[168:169], v[168:169], v[170:171]
    v_pk_add_f32 v[160:161], v[160:161], v[164:165]
    s_waitcnt lgkmcnt(0)
    v_pk_add_f32 v[172:173], v[172:173], v[174:175]
    v_pk_add_f32 v[160:161], v[160:161], v[168:169]
    v_pk_add_f32 v[160:161], v[160:161], v[172:173]
    v_cvt_pk_bf16_f32 v6, v160, v161
    s_nop 1
    v_mov_b32_dpp v40, v6 quad_perm:[0,0,0,0] row_mask:0xf bank_mask:0xf
    v_mov_b32_dpp v41, v6 quad_perm:[1,1,1,1] row_mask:0xf bank_mask:0xf
    v_mov_b32_dpp v42, v6 quad_perm:[2,2,2,2] row_mask:0xf bank_mask:0xf
    v_mov_b32_dpp v43, v6 quad_perm:[3,3,3,3] row_mask:0xf bank_mask:0xf
    s_nop 1
    v_smfmac_f32_16x16x64_bf16 v[128:131], v[40:43], v[192:199], v38
    v_smfmac_f32_16x16x64_bf16 v[144:147], v[40:43], v[224:231], v38
    v_smfmac_f32_16x16x64_bf16 v[136:139], v[40:43], v[208:215], v38
    v_smfmac_f32_16x16x64_bf16 v[152:155], v[40:43], v[240:247], v38
    v_smfmac_f32_16x16x64_bf16 v[132:135], v[40:43], v[200:207], v38
    v_smfmac_f32_16x16x64_bf16 v[148:151], v[40:43], v[232:239], v38
    v_smfmac_f32_16x16x64_bf16 v[140:143], v[40:43], v[216:223], v38
    v_smfmac_f32_16x16x64_bf16 v[156:159], v[40:43], v[248:255], v38
    s_nop 1
    v_permlane32_swap_b32 v128, v144
    v_add_f32 v20, v128, v144
    v_permlane32_swap_b32 v136, v152
    v_add_f32 v22, v136, v152
    v_permlane32_swap_b32 v132, v148
    v_add_f32 v21, v132, v148
    v_permlane16_swap_b32 v20, v22
    v_permlane32_swap_b32 v140, v156
    v_add_f32 v23, v140, v156
    v_add_f32_dpp v20, v22, v20 row_ror:8 row_mask:0xf bank_mask:0xf
    s_mov_b32 s68, 0x00ff00ff
    v_permlane16_swap_b32 v21, v23
    s_mov_b32 s69, 0x00ff00ff
    s_nop 0
    v_add_f32_dpp v21, v23, v21 row_ror:8 row_mask:0xf bank_mask:0xf
    v_cvt_pk_bf16_f32 v20, v20, v21
    v_min_u32 v20, -2, v20
    s_mov_b64 exec, s[68:69]
    global_store_dword v48, v20, s[60:61] sc1
    s_mov_b64 exec, -1
    s_barrier
    s_mov_b32 s36, s24
    s_and_b32 s37, s25, 0xffff
    s_mov_b32 s38, 0x158000
    s_mov_b32 s39, 0x20000
    s_cmp_ge_u32 s1, 22
    s_cbranch_scc1 L_help
    v_mov_b32 v30, v10
    v_mov_b32 v8, 0
    v_mov_b32 v10, 0
    v_mov_b32 v9, 0
    global_load_short_d16_hi v8, v53, s[8:9]
    global_load_short_d16_hi v9, v53, s[26:27]
    global_load_short_d16_hi v10, v30, s[22:23]
    s_add_u32 s7, s10, 121088
    buffer_load_dwordx2 v[92:93], v56, s[44:47], s7 offen
    buffer_load_dwordx2 v[94:95], v56, s[44:47], s7 offen offset:2752
    s_xor_b32 s7, s11, 0x0
    buffer_load_dwordx4 v[96:99], v57, s[36:39], s7 offen
    s_xor_b32 s7, s11, 0x8000
    buffer_load_dwordx4 v[100:103], v57, s[36:39], s7 offen
    s_xor_b32 s7, s11, 0x800
    buffer_load_dwordx4 v[104:107], v57, s[36:39], s7 offen
    s_mov_b64 s[66:67], s[60:61]
    s_cmp_lt_u32 s71, 32
    s_cbranch_scc1 L_chk
L_chkok:
    s_waitcnt vmcnt(3)
    v_perm_b32 v192, v66, v64, s56
    v_perm_b32 v193, v70, v68, s56
    v_perm_b32 v194, v74, v72, s56
    v_perm_b32 v195, v78, v76, s56
    v_perm_b32 v196, v82, v80, s56
    v_perm_b32 v197, v86, v84, s56
    v_perm_b32 v198, v90, v88, s56
    v_perm_b32 v199, v94, v92, s56
    v_perm_b32 v200, v66, v64, s57
    v_perm_b32 v201, v70, v68, s57
    v_perm_b32 v202, v74, v72, s57
    v_perm_b32 v203, v78, v76, s57
    v_perm_b32 v204, v82, v80, s57
    v_perm_b32 v205, v86, v84, s57
    v_perm_b32 v206, v90, v88, s57
    v_perm_b32 v207, v94, v92, s57
    v_perm_b32 v208, v67, v65, s56
    v_perm_b32 v209, v71, v69, s56
    v_perm_b32 v210, v75, v73, s56
    v_perm_b32 v211, v79, v77, s56
    v_perm_b32 v212, v83, v81, s56
    v_perm_b32 v213, v87, v85, s56
    v_perm_b32 v214, v91, v89, s56
    v_perm_b32 v215, v95, v93, s56
    v_perm_b32 v216, v67, v65, s57
    v_perm_b32 v217, v71, v69, s57
    v_perm_b32 v218, v75, v73, s57
    v_perm_b32 v219, v79, v77, s57
    v_perm_b32 v220, v83, v81, s57
    v_perm_b32 v221, v87, v85, s57
    v_perm_b32 v222, v91, v89, s57
    v_perm_b32 v223, v95, v93, s57
    v_mov_b32 v128, 0
    v_mov_b32 v132, 0
    v_mov_b32 v136, 0
    v_mov_b32 v140, 0
    s_add_u32 s60, s60, s70
    s_addc_u32 s61, s61, 0
    s_lshl_b32 s7, s1, 8
    s_sub_u32 s7, 16256, s7
    v_cmp_gt_u32_e64 s[58:59], s7, v52
    s_waitcnt vmcnt(8)
    global_load_dwordx4 v[176:179], v54, s[66:67] offset:0 sc1
    global_load_dwordx4 v[180:183], v54, s[66:67] offset:1024 sc1
    global_load_dwordx4 v[184:187], v54, s[66:67] offset:2048 sc1
    global_load_dwordx4 v[188:191], v54, s[66:67] offset:3072 sc1
    v_mov_b32 v20, 0
    v_mov_b32 v21, 0
    v_mov_b32 v22, 0
    v_mov_b32 v23, 0
    s_mov_b32 s64, 200000
    s_waitcnt vmcnt(0)
L_poll_y:
    v_smfmac_f32_16x16x64_bf16 v[20:23], v[12:15], v[176:183], v39
    v_smfmac_f32_16x16x64_bf16 v[20:23], v[12:15], v[184:191], v39
    v_cmp_eq_u32_e64 s[12:13], -1, v179
    v_cmp_eq_u32_e64 s[14:15], -1, v183
    v_cmp_eq_u32_e64 s[16:17], -1, v187
    v_cmp_eq_u32_e64 s[18:19], -1, v191
    s_or_b64 vcc, s[12:13], s[14:15]
    s_or_b64 s[68:69], s[16:17], s[18:19]
    s_or_b64 vcc, vcc, s[68:69]
    s_cbranch_scc0 L_pollsum_y
    v_mov_b32 v20, 0
    v_mov_b32 v21, 0
    v_mov_b32 v22, 0
    v_mov_b32 v23, 0
L_repoll_y:
    s_mov_b64 exec, s[12:13]
    s_cbranch_execz L_sky0
    global_load_dwordx4 v[176:179], v54, s[66:67] offset:0 sc1
L_sky0:
    s_mov_b64 exec, s[14:15]
    s_cbranch_execz L_sky1
    global_load_dwordx4 v[180:183], v54, s[66:67] offset:1024 sc1
L_sky1:
    s_mov_b64 exec, s[16:17]
    s_cbranch_execz L_sky2
    global_load_dwordx4 v[184:187], v54, s[66:67] offset:2048 sc1
L_sky2:
    s_mov_b64 exec, s[18:19]
    s_cbranch_execz L_sky3
    global_load_dwordx4 v[188:191], v54, s[66:67] offset:3072 sc1
L_sky3:
    s_mov_b64 exec, -1
    s_sub_u32 s64, s64, 1
    s_cmp_lg_u32 s64, 0
    s_waitcnt vmcnt(0)
    s_cbranch_scc1 L_poll_y
L_pollok_y:
    v_smfmac_f32_16x16x64_bf16 v[20:23], v[12:15], v[176:183], v39
    v_smfmac_f32_16x16x64_bf16 v[20:23], v[12:15], v[184:191], v39
    s_nop 7
L_pollsum_y:
    v_add_f32_dpp v28, v20, v20 row_ror:8 row_mask:0x5 bank_mask:0x3
    v_add_f32_dpp v28, v21, v21 row_ror:8 row_mask:0x5 bank_mask:0xc
    v_add_f32_dpp v28, v22, v22 row_ror:8 row_mask:0xa bank_mask:0x3
    v_add_f32_dpp v28, v23, v23 row_ror:8 row_mask:0xa bank_mask:0xc
    v_cmp_u_f32 vcc, v28, v28
    s_cbranch_vccnz L_pollnan_y
L_pollend_y:
    v_add_f32 v28, v28, v8
    v_cvt_pk_bf16_f32 v11, v28, v28
    s_nop 0
    v_mov_b32_dpp v29, v28 row_ror:8 row_mask:0xf bank_mask:0xf
    v_cvt_pk_bf16_f32 v6, v28, v29
    v_and_b32 v11, 0xffff0000, v11
    s_nop 0
    v_mov_b32_dpp v60, v6 quad_perm:[0,0,0,0] row_mask:0xf bank_mask:0x3
    v_mov_b32_dpp v61, v6 quad_perm:[1,1,1,1] row_mask:0xf bank_mask:0x3
    v_mov_b32_dpp v62, v6 quad_perm:[2,2,2,2] row_mask:0xf bank_mask:0x3
    v_mov_b32_dpp v63, v6 quad_perm:[3,3,3,3] row_mask:0xf bank_mask:0x3
    s_nop 1
    v_mfma_f32_16x16x32_bf16 v[16:19], v[60:63], v[60:63], 0
    v_smfmac_f32_16x16x64_bf16 v[128:131], v[60:63], v[192:199], v59
    v_smfmac_f32_16x16x64_bf16 v[136:139], v[60:63], v[208:215], v59
    v_smfmac_f32_16x16x64_bf16 v[132:135], v[60:63], v[200:207], v59
    v_smfmac_f32_16x16x64_bf16 v[140:143], v[60:63], v[216:223], v59
    s_nop 3
    ds_write_b32 v49, v16 offset:10368
    s_nop 0
    v_permlane16_swap_b32 v128, v136
    v_add_f32 v20, v128, v136
    v_permlane16_swap_b32 v132, v140
    v_add_f32 v21, v132, v140
    ds_write_b64 v51, v[20:21] offset:10752
    s_xor_b32 s7, s11, 0x8800
    buffer_load_dwordx4 v[108:111], v57, s[36:39], s7 offen
    s_xor_b32 s7, s11, 0x1000
    buffer_load_dwordx4 v[112:115], v57, s[36:39], s7 offen
    s_xor_b32 s7, s11, 0x9000
    buffer_load_dwordx4 v[116:119], v57, s[36:39], s7 offen
    s_xor_b32 s7, s11, 0x1800
    buffer_load_dwordx4 v[120:123], v57, s[36:39], s7 offen
    s_xor_b32 s7, s11, 0x9800
    buffer_load_dwordx4 v[124:127], v57, s[36:39], s7 offen
    s_waitcnt lgkmcnt(0)
    s_barrier
    ds_read_b64 v[24:25], v50 offset:10368
    ds_read2st64_b32 v[160:161], v52 offset0:0 offset1:8
    ds_read2st64_b32 v[162:163], v52 offset0:1 offset1:9
    ds_read2st64_b32 v[164:165], v52 offset0:2 offset1:10
    ds_read2st64_b32 v[166:167], v52 offset0:3 offset1:11
    ds_read2st64_b32 v[168:169], v52 offset0:4 offset1:12
    ds_read2st64_b32 v[170:171], v52 offset0:5 offset1:13
    ds_read2st64_b32 v[172:173], v52 offset0:6 offset1:14
    ds_read2st64_b32 v[174:175], v52 offset0:7 offset1:15
    v_mov_b32 v20, 0
    v_mov_b32 v21, 0
    v_mov_b32 v22, 0
    v_mov_b32 v23, 0
    s_waitcnt lgkmcnt(8)
    v_add_f32_dpp v24, v24, v24 row_ror:8 row_mask:0xf bank_mask:0xf
    v_add_f32_dpp v25, v25, v25 row_ror:8 row_mask:0xf bank_mask:0xf
    s_waitcnt lgkmcnt(6)
    v_pk_add_f32 v[160:161], v[160:161], v[162:163]
    v_add_f32_dpp v24, v24, v24 row_ror:4 row_mask:0xf bank_mask:0xf
    v_add_f32_dpp v25, v25, v25 row_ror:4 row_mask:0xf bank_mask:0xf
    s_waitcnt lgkmcnt(4)
    v_pk_add_f32 v[164:165], v[164:165], v[166:167]
    v_add_f32_dpp v24, v24, v24 row_ror:2 row_mask:0xf bank_mask:0xf
    v_add_f32_dpp v25, v25, v25 row_ror:2 row_mask:0xf bank_mask:0xf
    s_waitcnt lgkmcnt(2)
    v_pk_add_f32 v[168:169], v[168:169], v[170:171]
    v_add_f32_dpp v24, v24, v24 row_ror:1 row_mask:0xf bank_mask:0xf
    v_add_f32_dpp v25, v25, v25 row_ror:1 row_mask:0xf bank_mask:0xf
    v_pk_add_f32 v[160:161], v[160:161], v[164:165]
    v_mul_f32 v24, 0x3b000000, v24
    v_mul_f32 v25, 0x3b000000, v25
    s_waitcnt lgkmcnt(0)
    v_pk_add_f32 v[172:173], v[172:173], v[174:175]
    v_fma_f32 v25, -v24, v24, v25
    v_pk_add_f32 v[160:161], v[160:161], v[168:169]
    v_max_f32 v25, 0, v25
    v_pk_add_f32 v[160:161], v[160:161], v[172:173]
    v_add_f32 v25, 0x3727c5ac, v25
    v_rsq_f32 v25, v25
    v_fma_f32 v160, -v24, v161, v160
    v_fma_f32 v160, v160, v25, v10
    v_mul_f32 v161, v160, v160
    v_mul_f32 v162, 0xc0135761, v160
    v_mul_f32 v161, 0x3d372713, v161
    v_fma_f32 v161, v161, v162, v162
    v_exp_f32 v161, v161
    v_cndmask_b32_e64 v160, 0, v160, s[58:59]
    v_add_f32 v161, 1.0, v161
    v_rcp_f32 v161, v161
    s_nop 0
    v_mul_legacy_f32 v160, v160, v161
    v_cvt_pk_bf16_f32 v6, v160, v160
    v_cvt_pk_bf16_f32 v7, v160, v160
    s_nop 0
    v_mov_b32_dpp v6, v6 row_ror:8 row_mask:0xf bank_mask:0xc
    v_mov_b32_dpp v7, v7 row_ror:8 row_mask:0xf bank_mask:0x3
    s_nop 0
    v_and_b32_dpp v16, v6, v36 quad_perm:[0,0,0,0] row_mask:0xf bank_mask:0xf
    v_and_b32_dpp v17, v6, v37 quad_perm:[0,0,0,0] row_mask:0xf bank_mask:0xf
    v_and_b32_dpp v18, v6, v36 quad_perm:[1,1,1,1] row_mask:0xf bank_mask:0xf
    v_and_b32_dpp v19, v6, v37 quad_perm:[1,1,1,1] row_mask:0xf bank_mask:0xf
    v_and_b32_dpp v40, v6, v36 quad_perm:[2,2,2,2] row_mask:0xf bank_mask:0xf
    v_and_b32_dpp v41, v6, v37 quad_perm:[2,2,2,2] row_mask:0xf bank_mask:0xf
    v_and_b32_dpp v42, v6, v36 quad_perm:[3,3,3,3] row_mask:0xf bank_mask:0xf
    v_and_b32_dpp v43, v6, v37 quad_perm:[3,3,3,3] row_mask:0xf bank_mask:0xf
    v_smfmac_f32_16x16x64_bf16 v[20:23], v[16:19], v[96:103], v39
    v_and_b32_dpp v60, v7, v36 quad_perm:[0,0,0,0] row_mask:0xf bank_mask:0xf
    v_and_b32_dpp v61, v7, v37 quad_perm:[0,0,0,0] row_mask:0xf bank_mask:0xf
    v_and_b32_dpp v62, v7, v36 quad_perm:[1,1,1,1] row_mask:0xf bank_mask:0xf
    v_and_b32_dpp v63, v7, v37 quad_perm:[1,1,1,1] row_mask:0xf bank_mask:0xf
    s_waitcnt vmcnt(4)
    v_smfmac_f32_16x16x64_bf16 v[20:23], v[40:43], v[104:111], v39
    v_and_b32_dpp v16, v7, v36 quad_perm:[2,2,2,2] row_mask:0xf bank_mask:0xf
    v_and_b32_dpp v17, v7, v37 quad_perm:[2,2,2,2] row_mask:0xf bank_mask:0xf
    v_and_b32_dpp v18, v7, v36 quad_perm:[3,3,3,3] row_mask:0xf bank_mask:0xf
    v_and_b32_dpp v19, v7, v37 quad_perm:[3,3,3,3] row_mask:0xf bank_mask:0xf
    s_waitcnt vmcnt(2)
    v_smfmac_f32_16x16x64_bf16 v[20:23], v[60:63], v[112:119], v39
    s_waitcnt vmcnt(0)
    v_smfmac_f32_16x16x64_bf16 v[20:23], v[16:19], v[120:127], v39
    s_mov_b32 s68, 0x00ff00ff
    s_mov_b32 s69, 0x00ff00ff
    s_nop 5
    v_permlane16_swap_b32 v20, v22
    v_permlane16_swap_b32 v21, v23
    s_nop 0
    v_add_f32_dpp v20, v22, v20 row_ror:8 row_mask:0xf bank_mask:0xf
    v_add_f32_dpp v21, v23, v21 row_ror:8 row_mask:0xf bank_mask:0xf
    v_cvt_pk_bf16_f32 v20, v20, v21
    v_min_u32 v20, -2, v20
    s_mov_b64 exec, s[68:69]
    global_store_dword v48, v20, s[60:61] sc1
    s_mov_b64 exec, -1
    s_cmp_lg_u32 s3, s1
    s_cbranch_scc1 L_fin
    s_mov_b64 s[66:67], s[60:61]
    v_add_f32 v11, v11, v9
    s_waitcnt vmcnt(0)
    global_load_dwordx4 v[176:179], v54, s[66:67] offset:0 sc1
    global_load_dwordx4 v[180:183], v54, s[66:67] offset:1024 sc1
    global_load_dwordx4 v[184:187], v54, s[66:67] offset:2048 sc1
    global_load_dwordx4 v[188:191], v54, s[66:67] offset:3072 sc1
    v_mov_b32 v20, 0
    v_mov_b32 v21, 0
    v_mov_b32 v22, 0
    v_mov_b32 v23, 0
    s_mov_b32 s64, 200000
    s_waitcnt vmcnt(0)
L_poll_z:
    v_smfmac_f32_16x16x64_bf16 v[20:23], v[12:15], v[176:183], v39
    v_smfmac_f32_16x16x64_bf16 v[20:23], v[12:15], v[184:191], v39
    v_cmp_eq_u32_e64 s[12:13], -1, v179
    v_cmp_eq_u32_e64 s[14:15], -1, v183
    v_cmp_eq_u32_e64 s[16:17], -1, v187
    v_cmp_eq_u32_e64 s[18:19], -1, v191
    s_or_b64 vcc, s[12:13], s[14:15]
    s_or_b64 s[68:69], s[16:17], s[18:19]
    s_or_b64 vcc, vcc, s[68:69]
    s_cbranch_scc0 L_pollsum_z
    v_mov_b32 v20, 0
    v_mov_b32 v21, 0
    v_mov_b32 v22, 0
    v_mov_b32 v23, 0
L_repoll_z:
    s_mov_b64 exec, s[12:13]
    s_cbranch_execz L_skz0
    global_load_dwordx4 v[176:179], v54, s[66:67] offset:0 sc1
L_skz0:
    s_mov_b64 exec, s[14:15]
    s_cbranch_execz L_skz1
    global_load_dwordx4 v[180:183], v54, s[66:67] offset:1024 sc1
L_skz1:
    s_mov_b64 exec, s[16:17]
    s_cbranch_execz L_skz2
    global_load_dwordx4 v[184:187], v54, s[66:67] offset:2048 sc1
L_skz2:
    s_mov_b64 exec, s[18:19]
    s_cbranch_execz L_skz3
    global_load_dwordx4 v[188:191], v54, s[66:67] offset:3072 sc1
L_skz3:
    s_mov_b64 exec, -1
    s_sub_u32 s64, s64, 1
    s_cmp_lg_u32 s64, 0
    s_waitcnt vmcnt(0)
    s_cbranch_scc1 L_poll_z
L_pollok_z:
    v_smfmac_f32_16x16x64_bf16 v[20:23], v[12:15], v[176:183], v39
    v_smfmac_f32_16x16x64_bf16 v[20:23], v[12:15], v[184:191], v39
    s_nop 7
L_pollsum_z:
    v_add_f32_dpp v28, v20, v20 row_ror:8 row_mask:0x5 bank_mask:0x3
    v_add_f32_dpp v28, v21, v21 row_ror:8 row_mask:0x5 bank_mask:0xc
    v_add_f32_dpp v28, v22, v22 row_ror:8 row_mask:0xa bank_mask:0x3
    v_add_f32_dpp v28, v23, v23 row_ror:8 row_mask:0xa bank_mask:0xc
    v_cmp_u_f32 vcc, v28, v28
    s_cbranch_vccnz L_pollnan_z
L_pollend_z:
    v_add_f32 v28, v28, v11
    v_cvt_pk_bf16_f32 v28, v28, v28
    global_store_short v53, v28, s[28:29]
L_fin:
L_end:
s_endpgm
L_chk:
    s_mov_b32 s64, 200000
    v_mov_b32 v34, s6
L_chk2:
    global_load_dword v58, v34, s[30:31] sc1
    s_sub_u32 s64, s64, 1
    s_waitcnt vmcnt(0)
    v_cmp_gt_u32 vcc, 32, v58
    s_cbranch_vccz L_chkok
    s_cmp_lg_u32 s64, 0
    s_cbranch_scc1 L_chk2
    s_branch L_chkok
L_help:
    s_cmp_lg_u32 s1, 31
    s_cbranch_scc1 L_nohelpb
    s_and_b32 s62, s4, 1
    s_lshl_b32 s62, s62, 5
    s_and_b32 s63, s4, 6
    s_or_b32 s62, s62, s63
    s_lshl_b32 s62, s62, 10
    s_lshl_b32 s63, s3, 7
    s_add_u32 s62, s62, s63
    s_add_u32 s7, s5, 8
    s_and_b32 s7, s7, 28
    s_or_b32 s7, s7, 2
    s_add_u32 s63, s7, 2
    s_lshr_b32 s63, s63, 2
    s_sub_u32 s7, s7, s63
    s_lshl_b32 s7, s7, 16
    s_add_u32 s7, s7, s62
    buffer_load_dwordx4 v[100:103], v57, s[36:39], s7 offen sc1
    s_add_u32 s7, s5, 16
    s_and_b32 s7, s7, 28
    s_or_b32 s7, s7, 3
    s_add_u32 s63, s7, 2
    s_lshr_b32 s63, s63, 2
    s_sub_u32 s7, s7, s63
    s_lshl_b32 s7, s7, 16
    s_add_u32 s7, s7, s62
    buffer_load_dwordx4 v[104:107], v57, s[36:39], s7 offen sc1
    s_add_u32 s7, s5, 24
    s_and_b32 s7, s7, 28
    s_or_b32 s7, s7, 0
    s_add_u32 s63, s7, 2
    s_lshr_b32 s63, s63, 2
    s_sub_u32 s7, s7, s63
    s_lshl_b32 s7, s7, 16
    s_add_u32 s7, s7, s62
    buffer_load_dwordx4 v[108:111], v57, s[36:39], s7 offen sc1
L_nohelpb:
    s_branch L_fin
L_pollnan_y:
    s_cmp_eq_u32 s64, 0
    s_cbranch_scc1 L_pollend_y
    s_waitcnt vmcnt(0)
    v_mov_b32 v20, 0
    v_mov_b32 v21, 0
    v_mov_b32 v22, 0
    v_mov_b32 v23, 0
    v_max3_u32 v24, v176, v177, v178
    v_max_u32 v24, v24, v179
    v_cmp_eq_u32_e64 s[12:13], -1, v24
    v_max3_u32 v24, v180, v181, v182
    v_max_u32 v24, v24, v183
    v_cmp_eq_u32_e64 s[14:15], -1, v24
    v_max3_u32 v24, v184, v185, v186
    v_max_u32 v24, v24, v187
    v_cmp_eq_u32_e64 s[16:17], -1, v24
    v_max3_u32 v24, v188, v189, v190
    v_max_u32 v24, v24, v191
    v_cmp_eq_u32_e64 s[18:19], -1, v24
    s_or_b64 vcc, s[12:13], s[14:15]
    s_or_b64 s[68:69], s[16:17], s[18:19]
    s_or_b64 vcc, vcc, s[68:69]
    s_cbranch_scc1 L_repoll_y
    s_mov_b32 s64, 0
    s_branch L_pollok_y
L_pollnan_z:
    s_cmp_eq_u32 s64, 0
    s_cbranch_scc1 L_pollend_z
    s_waitcnt vmcnt(0)
    v_mov_b32 v20, 0
    v_mov_b32 v21, 0
    v_mov_b32 v22, 0
    v_mov_b32 v23, 0
    v_max3_u32 v24, v176, v177, v178
    v_max_u32 v24, v24, v179
    v_cmp_eq_u32_e64 s[12:13], -1, v24
    v_max3_u32 v24, v180, v181, v182
    v_max_u32 v24, v24, v183
    v_cmp_eq_u32_e64 s[14:15], -1, v24
    v_max3_u32 v24, v184, v185, v186
    v_max_u32 v24, v24, v187
    v_cmp_eq_u32_e64 s[16:17], -1, v24
    v_max3_u32 v24, v188, v189, v190
    v_max_u32 v24, v24, v191
    v_cmp_eq_u32_e64 s[18:19], -1, v24
    s_or_b64 vcc, s[12:13], s[14:15]
    s_or_b64 s[68:69], s[16:17], s[18:19]
    s_or_b64 vcc, vcc, s[68:69]
    s_cbranch_scc1 L_repoll_z
    s_mov_b32 s64, 0
    s_branch L_pollok_z
.fill 2112, 4, 0xbf800000
.section .rodata,"a"
.p2align 6
.amdhsa_kernel sequential_preLN__sliding_block_cached__dense_activation_gelu__decode_kernel
  .amdhsa_next_free_vgpr 256
  .amdhsa_next_free_sgpr 80
  .amdhsa_accum_offset 256
  .amdhsa_group_segment_fixed_size 0
  .amdhsa_kernarg_size 104
  .amdhsa_user_sgpr_count 2
  .amdhsa_user_sgpr_kernarg_segment_ptr 1
  .amdhsa_system_sgpr_workgroup_id_x 1
  .amdhsa_float_denorm_mode_32 3
.end_amdhsa_kernel
```
